```python
import torch

def _softmax(x, axis=-1):
    return torch.softmax(x, dim=axis)
def _gelu(x):
    return torch.nn.functional.gelu(x, approximate="tanh")
def _silu(x):
    return torch.nn.functional.silu(x)
def _sigmoid(x):
    return torch.sigmoid(x)
def _layernorm(x, axis=-1, eps=1e-5):
    m = x.mean(dim=axis, keepdim=True)
    v = x.var(dim=axis, keepdim=True, unbiased=False)
    return (x - m) / torch.sqrt(v + eps)
def _scatter_add(tgt, idx, src, axis=0):
    return tgt.clone().index_add_(axis, idx, src)
def _segment_sum(src, seg, n):
    out = torch.zeros((n,) + src.shape[1:], dtype=src.dtype)
    return out.index_add_(0, seg, src)
def _pad(x, pw):
    flat = tuple(v for pair in reversed(pw) for v in pair)
    return torch.nn.functional.pad(x, flat)

kernel_name = 'gated_mix__sliding_local_dilated__dense_activation_mish__prompt'

def setup_inputs():

    _w = (lambda a: (lambda t: t.to(torch.bfloat16) if t.is_floating_point() else t)(torch.as_tensor(a)))
    def _A_setup():
        B, S, D = 1, 2048, 640
        return {
            "x": _w((lambda *s: torch.randn(*s, dtype=torch.bfloat16) * 0.05)(B, S, D)),
            "wqkv": _w((lambda *s: torch.randn(*s, dtype=torch.bfloat16) * 0.8)(D, 3 * D)),
            "wo": _w((lambda *s: torch.randn(*s, dtype=torch.bfloat16) * 0.05)(D, D)),
        }
    _A_in = _A_setup()

    def _B_setup():
        B, S, D, F = 1, 2048, 640, 1728
        return {
            "x": _w((lambda *s: torch.randn(*s, dtype=torch.bfloat16) * 0.05)(B, S, D)),
            "w1": _w((lambda *s: torch.randn(*s, dtype=torch.bfloat16) * 12.8)(D, F) * (D ** -0.5)),
            "b1": _w((lambda *s: torch.randn(*s, dtype=torch.bfloat16) * 0.8)(F)),
            "w2": _w((lambda *s: torch.randn(*s, dtype=torch.bfloat16) * 0.8)(F, D) * (F ** -0.5)),
        }
    _B_in = _B_setup()

    return {
        "A_x": _A_in["x"],
        "A_wqkv": _A_in["wqkv"],
        "A_wo": _A_in["wo"],
        "B_x": _B_in["x"],
        "B_w1": _B_in["w1"],
        "B_b1": _B_in["b1"],
        "B_w2": _B_in["w2"],
        "gate_w": _w((lambda *s: torch.randn(*s, dtype=torch.bfloat16) * 0.05)(640) * 16.0),
    }

def reference(A_x, A_wqkv, A_wo, B_x, B_w1, B_b1, B_w2, gate_w):
    def _A_ref(x, wqkv, wo):
        B, S, D = x.shape
        H = 32; Dh = D // H
        W, dil = 8, 2
        qkv = (lambda x, *d: x.permute(*d))((x @ wqkv).reshape(B, S, 3, H, Dh), 2, 0, 3, 1, 4)
        q, k, v = qkv[0], qkv[1], qkv[2]
        scale = Dh ** -0.5
        pos = torch.arange(S)
        off = torch.arange(W) * dil
        idx = pos[:, None] - off[None, :]
        mask = idx >= 0
        idx_c = torch.where(mask, idx, 0).reshape(-1)
        kg = k[:, :, idx_c, :].reshape(B, H, S, W, Dh)
        vg = v[:, :, idx_c, :].reshape(B, H, S, W, Dh)
        logits = torch.einsum("bhsd,bhswd->bhsw", q, kg) * scale
        logits = torch.where(mask[None, None, :, :], logits, -1e9)
        attn = _softmax(logits, axis=-1)
        o = torch.einsum("bhsw,bhswd->bhsd", attn, vg)
        return (lambda x, *d: x.permute(*d))(o, 0, 2, 1, 3).reshape(B, S, D) @ wo

    def _B_ref(x, w1, b1, w2):
        h = torch.einsum("bsd,df->bsf", x, w1) + b1
        sp = torch.log1p(torch.exp(-torch.abs(h))) + torch.where(h > 0, h, torch.zeros_like(h))
        act = h * torch.tanh(sp)
        return torch.einsum("bsf,fd->bsd", act, w2)

    x = A_x
    g = _sigmoid((x * gate_w).sum(-1, keepdims=True))
    a = _A_ref(x, A_wqkv, A_wo)
    b = _B_ref(x, B_w1, B_b1, B_w2)
    return g * a + (1 - g) * b
```

```asm
; @launch kernel=gmix_a_kernel grid=(256,1,1) block=(512,1,1) lds=147456
; @launch kernel=gmix_b_kernel grid=(256,1,1) block=(256,1,1) lds=61440
.amdgcn_target "amdgcn-amd-amdhsa--gfx950"
.text
.globl gmix_a_kernel
.p2align 8
.type gmix_a_kernel,@function
gmix_a_kernel:
    s_cmp_ge_u32 s2, 256
    s_cbranch_scc1 K1_done
    s_load_dwordx4 s[4:7], s[0:1], 0
    s_load_dwordx2 s[8:9], s[0:1], 16
    s_load_dwordx4 s[12:15], s[0:1], 32
    s_load_dwordx4 s[16:19], s[0:1], 48
    s_load_dwordx2 s[10:11], s[0:1], 80
    v_lshrrev_b32 v28, 6, v0
    v_and_b32 v9, 63, v0
    v_readfirstlane_b32 s41, v28
    s_and_b32 s3, s2, 7
    s_lshr_b32 s21, s2, 3
    s_lshr_b32 s22, s3, 1
    s_lshl_b32 s22, s22, 2
    s_lshr_b32 s23, s21, 3
    s_add_u32 s22, s22, s23
    s_and_b32 s21, s21, 7
    s_add_u32 s36, s23, s21
    s_and_b32 s36, s36, 3
    s_mul_i32 s37, s3, 5
    s_lshr_b32 s37, s37, 2
    s_add_u32 s36, s36, s37
    s_cmp_ge_u32 s36, 10
    s_cselect_b32 s37, 10, 0
    s_sub_u32 s36, s36, s37
    s_and_b32 s23, s3, 1
    s_lshl_b32 s23, s23, 2
    s_and_b32 s37, s21, 3
    s_add_u32 s23, s23, s37
    s_lshr_b32 s21, s21, 2
    s_and_b32 s20, s41, 3
    s_lshr_b32 s47, s41, 2
    v_and_b32 v20, 15, v9
    v_lshrrev_b32 v21, 4, v9
    s_mul_i32 s39, s41, 6144
    s_mov_b32 s27, 0x20000
    s_mov_b32 s31, 0x20000
    s_mov_b32 s26, 2621440
    s_cmp_eq_u32 s21, 1
    s_cbranch_scc1 K1_ffn
    s_add_u32 s48, s39, 147456
    s_add_u32 s46, s39, 98304
    s_mov_b32 s49, s39
    s_mul_i32 s37, s23, 160
    s_cmp_ge_u32 s41, 5
    s_cbranch_scc1 K1Q_aload
    s_mov_b32 s50, 245760
    s_mov_b32 s30, 2457600
    s_mul_i32 s38, s41, 384
    v_add_u32 v36, s38, v9
    v_add_u32 v32, 0, v36
    v_mul_u32_u24 v33, 0x889, v32
    v_lshrrev_b32 v33, 16, v33
    v_mul_u32_u24 v34, 30, v33
    v_sub_u32 v32, v32, v34
    v_and_b32 v34, 0x33, v33
    v_and_b32 v35, 4, v33
    v_lshl_or_b32 v34, v35, 1, v34
    v_and_b32 v35, 8, v33
    v_lshrrev_b32 v35, 1, v35
    v_or_b32 v33, v34, v35
    v_mul_u32_u24 v33, 3840, v33
    v_lshl_add_u32 v33, v32, 4, v33
    v_mul_u32_u24 v34, 0x667, v32
    v_lshrrev_b32 v34, 14, v34
    v_mul_u32_u24 v34, 1120, v34
    v_add3_u32 v33, v33, v34, s37
    v_subrev_u32 v1, 0, v33
    v_add_u32 v32, 64, v36
    v_mul_u32_u24 v33, 0x889, v32
    v_lshrrev_b32 v33, 16, v33
    v_mul_u32_u24 v34, 30, v33
    v_sub_u32 v32, v32, v34
    v_and_b32 v34, 0x33, v33
    v_and_b32 v35, 4, v33
    v_lshl_or_b32 v34, v35, 1, v34
    v_and_b32 v35, 8, v33
    v_lshrrev_b32 v35, 1, v35
    v_or_b32 v33, v34, v35
    v_mul_u32_u24 v33, 3840, v33
    v_lshl_add_u32 v33, v32, 4, v33
    v_mul_u32_u24 v34, 0x667, v32
    v_lshrrev_b32 v34, 14, v34
    v_mul_u32_u24 v34, 1120, v34
    v_add3_u32 v33, v33, v34, s37
    v_subrev_u32 v2, 1024, v33
    v_add_u32 v32, 128, v36
    v_mul_u32_u24 v33, 0x889, v32
    v_lshrrev_b32 v33, 16, v33
    v_mul_u32_u24 v34, 30, v33
    v_sub_u32 v32, v32, v34
    v_and_b32 v34, 0x33, v33
    v_and_b32 v35, 4, v33
    v_lshl_or_b32 v34, v35, 1, v34
    v_and_b32 v35, 8, v33
    v_lshrrev_b32 v35, 1, v35
    v_or_b32 v33, v34, v35
    v_mul_u32_u24 v33, 3840, v33
    v_lshl_add_u32 v33, v32, 4, v33
    v_mul_u32_u24 v34, 0x667, v32
    v_lshrrev_b32 v34, 14, v34
    v_mul_u32_u24 v34, 1120, v34
    v_add3_u32 v33, v33, v34, s37
    v_subrev_u32 v3, 2048, v33
    v_add_u32 v32, 192, v36
    v_mul_u32_u24 v33, 0x889, v32
    v_lshrrev_b32 v33, 16, v33
    v_mul_u32_u24 v34, 30, v33
    v_sub_u32 v32, v32, v34
    v_and_b32 v34, 0x33, v33
    v_and_b32 v35, 4, v33
    v_lshl_or_b32 v34, v35, 1, v34
    v_and_b32 v35, 8, v33
    v_lshrrev_b32 v35, 1, v35
    v_or_b32 v33, v34, v35
    v_mul_u32_u24 v33, 3840, v33
    v_lshl_add_u32 v33, v32, 4, v33
    v_mul_u32_u24 v34, 0x667, v32
    v_lshrrev_b32 v34, 14, v34
    v_mul_u32_u24 v34, 1120, v34
    v_add3_u32 v33, v33, v34, s37
    v_subrev_u32 v4, 0, v33
    v_add_u32 v32, 256, v36
    v_mul_u32_u24 v33, 0x889, v32
    v_lshrrev_b32 v33, 16, v33
    v_mul_u32_u24 v34, 30, v33
    v_sub_u32 v32, v32, v34
    v_and_b32 v34, 0x33, v33
    v_and_b32 v35, 4, v33
    v_lshl_or_b32 v34, v35, 1, v34
    v_and_b32 v35, 8, v33
    v_lshrrev_b32 v35, 1, v35
    v_or_b32 v33, v34, v35
    v_mul_u32_u24 v33, 3840, v33
    v_lshl_add_u32 v33, v32, 4, v33
    v_mul_u32_u24 v34, 0x667, v32
    v_lshrrev_b32 v34, 14, v34
    v_mul_u32_u24 v34, 1120, v34
    v_add3_u32 v33, v33, v34, s37
    v_subrev_u32 v5, 1024, v33
    v_add_u32 v32, 320, v36
    v_mul_u32_u24 v33, 0x889, v32
    v_lshrrev_b32 v33, 16, v33
    v_mul_u32_u24 v34, 30, v33
    v_sub_u32 v32, v32, v34
    v_and_b32 v34, 0x33, v33
    v_and_b32 v35, 4, v33
    v_lshl_or_b32 v34, v35, 1, v34
    v_and_b32 v35, 8, v33
    v_lshrrev_b32 v35, 1, v35
    v_or_b32 v33, v34, v35
    v_mul_u32_u24 v33, 3840, v33
    v_lshl_add_u32 v33, v32, 4, v33
    v_mul_u32_u24 v34, 0x667, v32
    v_lshrrev_b32 v34, 14, v34
    v_mul_u32_u24 v34, 1120, v34
    v_add3_u32 v33, v33, v34, s37
    v_subrev_u32 v6, 2048, v33
    s_waitcnt lgkmcnt(0)
    s_mov_b32 s28, s6
    s_mov_b32 s29, s7
    s_branch K1Q_loads
K1Q_aload:
    s_movk_i32 s50, 128
    s_mov_b32 s30, 2621440
    v_lshrrev_b32 v28, 3, v9
    v_and_b32 v29, 7, v9
    v_lshrrev_b32 v30, 1, v28
    v_xor_b32 v30, v29, v30
    v_xor_b32 v31, 4, v30
    s_sub_u32 s38, s41, 5
    s_mul_i32 s38, s38, 48
    s_lshl_b32 s62, s22, 7
    s_add_u32 s38, s38, s62
    v_add_u32 v28, s38, v28
    v_mul_u32_u24 v28, 0x500, v28
    v_lshl_add_u32 v30, v30, 4, v28
    v_lshl_add_u32 v31, v31, 4, v28
    s_cmp_eq_u32 s41, 7
    s_cselect_b32 s62, -184320, 0
    v_add_u32 v1, 0, v30
    v_add_u32 v2, 9216, v31
    v_add_u32 v3, 18432, v30
    v_add_u32 v4, 30720, v31
    v_add_u32 v5, 39936, v30
    v_add_u32 v5, s62, v5
    v_add_u32 v6, 49152, v31
    v_add_u32 v6, s62, v6
    s_waitcnt lgkmcnt(0)
    s_mov_b32 s28, s4
    s_mov_b32 s29, s5
K1Q_loads:
    s_mul_i32 s44, s36, s50
    s_mul_i32 s45, s50, 10
    s_mov_b32 s24, s4
    s_mov_b32 s25, s5
    s_mov_b32 m0, s49
    s_nop 0
    buffer_load_dwordx4 v1, s[28:31], s44 offen offset:0 lds
    buffer_load_dwordx4 v2, s[28:31], s44 offen offset:1024 lds
    buffer_load_dwordx4 v3, s[28:31], s44 offen offset:2048 lds
    s_add_u32 m0, m0, 3072
    s_nop 0
    buffer_load_dwordx4 v4, s[28:31], s44 offen offset:0 lds
    buffer_load_dwordx4 v5, s[28:31], s44 offen offset:1024 lds
    buffer_load_dwordx4 v6, s[28:31], s44 offen offset:2048 lds
    s_add_u32 s44, s44, s50
    s_cmp_eq_u32 s44, s45
    s_cselect_b32 s44, 0, s44
    s_add_u32 s49, s49, 49152
    s_cmp_eq_u32 s49, s48
    s_cselect_b32 s49, s39, s49
    s_mov_b32 m0, s49
    v_lshrrev_b32 v28, 5, v9
    v_lshlrev_b32 v28, 4, v28
    v_bfe_u32 v29, v9, 2, 3
    v_add_u32 v28, v28, v29
    v_mul_u32_u24 v28, 480, v28
    v_and_b32 v29, 3, v9
    v_lshl_add_u32 v27, v29, 3, v28
    v_lshrrev_b32 v30, 1, v20
    v_xor_b32 v30, v21, v30
    v_lshlrev_b32 v31, 7, v20
    v_lshl_add_u32 v30, v30, 4, v31
    v_xor_b32 v31, 64, v30
    s_lshl_b32 s63, s20, 12
    s_add_u32 s63, s63, 30720
    v_add_u32 v16, s63, v30
    v_add_u32 v17, s63, v31
    s_mov_b32 s51, 10
    s_mov_b32 s57, 49152
    s_mov_b32 s58, 1
    s_mov_b32 s59, 49152
    v_add_u32 v18, 47104, v30
    v_add_u32 v19, 47104, v31
    s_cmp_eq_u32 s47, 1
    s_cbranch_scc1 K1Q_n1
    s_mov_b32 s52, 0
    s_mov_b32 s53, 0
    s_mov_b32 s54, 0
    s_cmp_eq_u32 s20, 1
    s_cselect_b32 s52, 32, s52
    s_cselect_b32 s53, -32, s53
    s_cmp_eq_u32 s20, 2
    s_cselect_b32 s52, 64, s52
    s_cselect_b32 s54, -64, s54
    v_mov_b32 v10, v27
    v_mul_u32_u24 v30, 40, v29
    v_add3_u32 v11, v28, v30, 32
    v_add_u32 v12, s52, v27
    v_add_u32 v13, s53, v27
    v_add_u32 v14, s54, v27
    v_mov_b32 v32, 0
    v_mov_b32 v33, 0
    v_mov_b32 v34, 0
    v_mov_b32 v35, 0
    v_mov_b32 v36, 0
    v_mov_b32 v37, 0
    v_mov_b32 v38, 0
    v_mov_b32 v39, 0
    v_mov_b32 v40, 0
    v_mov_b32 v41, 0
    v_mov_b32 v42, 0
    v_mov_b32 v43, 0
    v_mov_b32 v44, 0
    v_mov_b32 v45, 0
    v_mov_b32 v46, 0
    v_mov_b32 v47, 0
    v_mov_b32 v48, 0
    v_mov_b32 v49, 0
    v_mov_b32 v50, 0
    v_mov_b32 v51, 0
    v_mov_b32 v52, 0
    v_mov_b32 v53, 0
    v_mov_b32 v54, 0
    v_mov_b32 v55, 0
    v_mov_b32 v56, 0
    v_mov_b32 v57, 0
    v_mov_b32 v58, 0
    v_mov_b32 v59, 0
    v_mov_b32 v60, 0
    v_mov_b32 v61, 0
    v_mov_b32 v62, 0
    v_mov_b32 v63, 0
    v_mov_b32 v64, 0
    v_mov_b32 v65, 0
    v_mov_b32 v66, 0
    v_mov_b32 v67, 0
    v_mov_b32 v68, 0
    v_mov_b32 v69, 0
    v_mov_b32 v70, 0
    v_mov_b32 v71, 0
    v_mov_b32 v72, 0
    v_mov_b32 v73, 0
    v_mov_b32 v74, 0
    v_mov_b32 v75, 0
    v_mov_b32 v76, 0
    v_mov_b32 v77, 0
    v_mov_b32 v78, 0
    v_mov_b32 v79, 0
    v_mov_b32 v80, 0
    v_mov_b32 v81, 0
    v_mov_b32 v82, 0
    v_mov_b32 v83, 0
    v_mov_b32 v84, 0
    v_mov_b32 v85, 0
    v_mov_b32 v86, 0
    v_mov_b32 v87, 0
    v_mov_b32 v88, 0
    v_mov_b32 v89, 0
    v_mov_b32 v90, 0
    v_mov_b32 v91, 0
    v_mov_b32 v92, 0
    v_mov_b32 v93, 0
    v_mov_b32 v94, 0
    v_mov_b32 v95, 0
    v_mov_b32 v96, 0
    v_mov_b32 v97, 0
    v_mov_b32 v98, 0
    v_mov_b32 v99, 0
    s_nop 0
    buffer_load_dwordx4 v1, s[28:31], s44 offen offset:0 lds
    buffer_load_dwordx4 v2, s[28:31], s44 offen offset:1024 lds
    buffer_load_dwordx4 v3, s[28:31], s44 offen offset:2048 lds
    s_add_u32 m0, m0, 3072
    s_nop 0
    buffer_load_dwordx4 v4, s[28:31], s44 offen offset:0 lds
    buffer_load_dwordx4 v5, s[28:31], s44 offen offset:1024 lds
    buffer_load_dwordx4 v6, s[28:31], s44 offen offset:2048 lds
    s_add_u32 s44, s44, s50
    s_cmp_eq_u32 s44, s45
    s_cselect_b32 s44, 0, s44
    s_add_u32 s49, s49, 49152
    s_cmp_eq_u32 s49, s48
    s_cselect_b32 s49, s39, s49
    s_mov_b32 m0, s49
    s_add_u32 s32, s10, 0
    s_addc_u32 s33, s11, 0
    s_mov_b32 s34, 9699328
    s_mov_b32 s35, 0x20000
    s_lshl_b32 s60, s22, 3
    s_lshl_b32 s61, s20, 1
    s_add_u32 s60, s60, s61
    s_lshr_b32 s61, s60, 2
    s_mul_i32 s61, s61, 296
    s_and_b32 s60, s60, 3
    s_add_u32 s60, s60, s61
    s_lshl_b32 s60, s60, 10
    s_lshl_b32 s62, s20, 5
    s_add_u32 s62, s62, 16
    v_add_u32 v120, s62, v20
    v_mul_u32_u24 v120, 336, v120
    v_lshl_add_u32 v120, v21, 3, v120
    v_mul_u32_u24 v126, 336, v20
    v_lshl_add_u32 v126, v21, 3, v126
    v_add_u32 v121, s52, v120
    v_add_u32 v122, s53, v120
    v_add_u32 v123, s54, v120
    v_add_u32 v127, s52, v126
    v_lshlrev_b32 v130, 4, v9
    s_lshl_b32 s62, s20, 12
    s_add_u32 s62, s62, 49152
    v_add_u32 v130, s62, v130
    v_cmp_eq_u32 s[72:73], 0, v21
    v_cmp_eq_u32 s[74:75], 1, v21
    v_cmp_eq_u32 s[76:77], 2, v21
    v_cmp_eq_u32 s[78:79], 3, v21
    v_mov_b32 v132, 0
    v_mov_b32 v133, 0
    v_and_b32 v131, 1, v21
    v_lshlrev_b32 v131, 3, v131
    v_lshlrev_b32 v134, 3, v21
    v_sub_u32 v131, v131, v134
    v_add_u32 v134, v120, v131
    v_add_u32 v135, v126, v131
    v_and_b32 v140, 1, v20
    v_lshl_add_u32 v141, v21, 2, v140
    v_cmp_eq_u32 s[84:85], 1, v140
    v_cmp_le_u32 s[86:87], v141, v20
    v_add_u32 v141, 2, v141
    v_cmp_le_u32 s[88:89], v141, v20
    v_mov_b32 v140, 0xffff
    v_mov_b32 v141, 0xffff0000
    v_cndmask_b32 v140, v140, v141, s[84:85]
    v_cndmask_b32 v142, 0, v140, s[86:87]
    v_cndmask_b32 v143, v140, 0, s[86:87]
    v_cndmask_b32 v144, 0, v140, s[88:89]
    v_cndmask_b32 v145, v140, 0, s[88:89]
    s_or_b32 s62, s22, s20
    s_cmp_eq_u32 s62, 0
    s_cselect_b32 s62, 0xf149f2ca, 0
    v_mov_b32 v140, s62
    v_cndmask_b32 v146, v140, 0, s[86:87]
    v_cndmask_b32 v147, v140, 0, s[88:89]
    s_lshl_b32 s62, s20, 5
    s_mul_i32 s63, s47, 80
    v_add_u32 v148, s62, v20
    v_mul_u32_u24 v148, 336, v148
    v_add_u32 v148, s63, v148
    v_add_u32 v149, 32, v148
    v_lshl_add_u32 v148, v21, 3, v148
    v_lshrrev_b32 v150, 2, v9
    v_add_u32 v150, s62, v150
    v_mul_u32_u24 v150, 336, v150
    v_and_b32 v151, 3, v9
    s_lshl_b32 s66, s47, 1
    s_add_u32 s67, s66, 0
    v_cmp_eq_u32 vcc, s67, v151
    s_add_u32 s67, s63, 192
    v_mov_b32 v140, s67
    v_mov_b32 v141, 320
    v_cndmask_b32 v140, v141, v140, vcc
    v_add_u32 v152, v150, v140
    s_add_u32 s67, s66, 1
    v_cmp_eq_u32 vcc, s67, v151
    s_add_u32 s67, s63, 232
    v_mov_b32 v140, s67
    v_mov_b32 v141, 320
    v_cndmask_b32 v140, v141, v140, vcc
    v_add_u32 v153, v150, v140
    v_lshl_add_u32 v150, v151, 3, v150
    v_add_u32 v150, s63, v150
    s_mul_i32 s62, s23, 20
    s_mul_i32 s63, s47, 10
    s_add_u32 s63, s63, s62
    s_add_u32 s67, s63, 0
    v_add_u32 v151, s67, v21
    v_lshrrev_b32 v140, 3, v151
    v_lshlrev_b32 v140, 12, v140
    v_and_b32 v141, 3, v151
    v_lshl_add_u32 v140, v141, 8, v140
    v_bfe_u32 v141, v151, 2, 1
    v_lshl_add_u32 v140, v141, 3, v140
    v_lshl_add_u32 v154, v20, 4, v140
    s_add_u32 s67, s63, 5
    v_add_u32 v151, s67, v21
    v_lshrrev_b32 v140, 3, v151
    v_lshlrev_b32 v140, 12, v140
    v_and_b32 v141, 3, v151
    v_lshl_add_u32 v140, v141, 8, v140
    v_bfe_u32 v141, v151, 2, 1
    v_lshl_add_u32 v140, v141, 3, v140
    v_lshl_add_u32 v155, v20, 4, v140
    v_mul_u32_u24 v151, 5, v21
    s_add_u32 s63, s62, 4
    v_add_u32 v151, s63, v151
    v_lshrrev_b32 v140, 3, v151
    v_lshlrev_b32 v140, 12, v140
    v_and_b32 v141, 3, v151
    v_lshl_add_u32 v140, v141, 8, v140
    v_bfe_u32 v141, v151, 2, 1
    v_lshl_add_u32 v140, v141, 3, v140
    v_lshl_add_u32 v156, v20, 4, v140
    s_mov_b32 s80, 0x3ea52b5c
    s_waitcnt vmcnt(6)
    s_barrier
    ds_read_b128 a[64:67], v16 offset:0
    ds_read_b128 a[68:71], v16 offset:2048
    ds_read_b128 a[72:75], v18
    ds_read_b64_tr_b16 a[0:1], v10 offset:0
    ds_read_b64_tr_b16 a[2:3], v10 offset:3840
    ds_read_b64_tr_b16 a[4:5], v10 offset:40
    ds_read_b64_tr_b16 a[6:7], v10 offset:3880
    ds_read_b64_tr_b16 a[8:9], v10 offset:80
    ds_read_b64_tr_b16 a[10:11], v10 offset:3920
    ds_read_b64_tr_b16 a[12:13], v10 offset:120
    ds_read_b64_tr_b16 a[14:15], v10 offset:3960
    ds_read_b64_tr_b16 a[16:17], v11 offset:0
    ds_read_b64_tr_b16 a[18:19], v11 offset:3840
    ds_read_b64_tr_b16 a[20:21], v12 offset:160
    ds_read_b64_tr_b16 a[22:23], v12 offset:4000
    ds_read_b64_tr_b16 a[24:25], v13 offset:192
    ds_read_b64_tr_b16 a[26:27], v13 offset:4032
    ds_read_b64_tr_b16 a[28:29], v14 offset:224
    ds_read_b64_tr_b16 a[30:31], v14 offset:4064
    buffer_load_dwordx4 v1, s[28:31], s44 offen offset:0 lds
    buffer_load_dwordx4 v2, s[28:31], s44 offen offset:1024 lds
    buffer_load_dwordx4 v3, s[28:31], s44 offen offset:2048 lds
    s_add_u32 m0, m0, 3072
K1Q0_loop:
    s_waitcnt lgkmcnt(12)
    v_mfma_f32_16x16x32_bf16 v[32:35], a[0:3], a[64:67], v[32:35]
    ds_read_b128 a[76:79], v17 offset:0
    ds_read_b128 a[80:83], v17 offset:2048
    v_mfma_f32_16x16x32_bf16 v[64:67], a[0:3], a[68:71], v[64:67]
    ds_read_b128 a[84:87], v19
    v_mfma_f32_16x16x32_bf16 v[36:39], a[4:7], a[64:67], v[36:39]
    ds_read_b64_tr_b16 a[32:33], v10 offset:15360
    buffer_load_dwordx4 v4, s[28:31], s44 offen offset:0 lds
    v_mfma_f32_16x16x32_bf16 v[68:71], a[4:7], a[68:71], v[68:71]
    ds_read_b64_tr_b16 a[34:35], v10 offset:19200
    s_waitcnt lgkmcnt(13)
    v_mfma_f32_16x16x32_bf16 v[40:43], a[8:11], a[64:67], v[40:43]
    ds_read_b64_tr_b16 a[36:37], v10 offset:15400
    v_mfma_f32_16x16x32_bf16 v[72:75], a[8:11], a[68:71], v[72:75]
    ds_read_b64_tr_b16 a[38:39], v10 offset:19240
    v_mfma_f32_16x16x32_bf16 v[44:47], a[12:15], a[64:67], v[44:47]
    ds_read_b64_tr_b16 a[40:41], v10 offset:15440
    v_mfma_f32_16x16x32_bf16 v[76:79], a[12:15], a[68:71], v[76:79]
    ds_read_b64_tr_b16 a[42:43], v10 offset:19280
    buffer_load_dwordx4 v5, s[28:31], s44 offen offset:1024 lds
    s_waitcnt lgkmcnt(13)
    v_mfma_f32_16x16x32_bf16 v[48:51], a[16:19], a[64:67], v[48:51]
    ds_read_b64_tr_b16 a[44:45], v10 offset:15480
    ds_read_b64_tr_b16 a[46:47], v10 offset:19320
    v_mfma_f32_16x16x32_bf16 v[80:83], a[16:19], a[68:71], v[80:83]
    ds_read_b64_tr_b16 a[48:49], v11 offset:15360
    v_mfma_f32_16x16x32_bf16 v[52:55], a[20:23], a[64:67], v[52:55]
    ds_read_b64_tr_b16 a[50:51], v11 offset:19200
    v_mfma_f32_16x16x32_bf16 v[84:87], a[20:23], a[68:71], v[84:87]
    ds_read_b64_tr_b16 a[52:53], v12 offset:15520
    v_mfma_f32_16x16x32_bf16 v[96:99], a[20:23], a[72:75], v[96:99]
    ds_read_b64_tr_b16 a[54:55], v12 offset:19360
    buffer_load_dwordx4 v6, s[28:31], s44 offen offset:2048 lds
    s_waitcnt lgkmcnt(14)
    v_mfma_f32_16x16x32_bf16 v[56:59], a[24:27], a[64:67], v[56:59]
    ds_read_b64_tr_b16 a[56:57], v13 offset:15552
    v_mfma_f32_16x16x32_bf16 v[88:91], a[24:27], a[68:71], v[88:91]
    ds_read_b64_tr_b16 a[58:59], v13 offset:19392
    v_mfma_f32_16x16x32_bf16 v[60:63], a[28:31], a[64:67], v[60:63]
    ds_read_b64_tr_b16 a[60:61], v14 offset:15584
    v_mfma_f32_16x16x32_bf16 v[92:95], a[28:31], a[68:71], v[92:95]
    ds_read_b64_tr_b16 a[62:63], v14 offset:19424
    s_waitcnt lgkmcnt(12)
    v_mfma_f32_16x16x32_bf16 v[32:35], a[32:35], a[76:79], v[32:35]
    s_add_u32 s44, s44, s50
    s_cmp_eq_u32 s44, s45
    s_cselect_b32 s44, 0, s44
    s_add_u32 s49, s49, 49152
    s_cmp_eq_u32 s49, s48
    s_cselect_b32 s49, s39, s49
    s_cmp_eq_u32 s49, s46
    s_cselect_b32 s57, -98304, s59
    v_mfma_f32_16x16x32_bf16 v[64:67], a[32:35], a[80:83], v[64:67]
    s_mov_b32 m0, s49
    s_cmp_le_u32 s51, 3
    s_cbranch_scc1 K1Q0_tail
K1Q0_tailed:
    v_add_u32 v10, s57, v10
    v_mfma_f32_16x16x32_bf16 v[36:39], a[36:39], a[76:79], v[36:39]
    v_add_u32 v11, s57, v11
    v_add_u32 v12, s57, v12
    v_mfma_f32_16x16x32_bf16 v[68:71], a[36:39], a[80:83], v[68:71]
    v_add_u32 v13, s57, v13
    v_add_u32 v14, s57, v14
    s_waitcnt lgkmcnt(8)
    v_mfma_f32_16x16x32_bf16 v[40:43], a[40:43], a[76:79], v[40:43]
    v_add_u32 v16, s57, v16
    v_add_u32 v17, s57, v17
    v_mfma_f32_16x16x32_bf16 v[72:75], a[40:43], a[80:83], v[72:75]
    v_add_u32 v18, s57, v18
    v_add_u32 v19, s57, v19
K1Q0_mid:
    s_waitcnt vmcnt(6) lgkmcnt(0)
    s_cmp_eq_u32 s51, 1
    s_barrier
    s_cbranch_scc1 K1Q0_last
    v_mfma_f32_16x16x32_bf16 v[44:47], a[44:47], a[76:79], v[44:47]
    ds_read_b128 a[64:67], v16 offset:0
    ds_read_b128 a[68:71], v16 offset:2048
    v_mfma_f32_16x16x32_bf16 v[76:79], a[44:47], a[80:83], v[76:79]
    ds_read_b128 a[72:75], v18
    ds_read_b64_tr_b16 a[0:1], v10 offset:0
    buffer_load_dwordx4 v1, s[28:31], s44 offen offset:0 lds
    v_mfma_f32_16x16x32_bf16 v[48:51], a[48:51], a[76:79], v[48:51]
    ds_read_b64_tr_b16 a[2:3], v10 offset:3840
    ds_read_b64_tr_b16 a[4:5], v10 offset:40
    v_mfma_f32_16x16x32_bf16 v[80:83], a[48:51], a[80:83], v[80:83]
    ds_read_b64_tr_b16 a[6:7], v10 offset:3880
    v_mfma_f32_16x16x32_bf16 v[52:55], a[52:55], a[76:79], v[52:55]
    ds_read_b64_tr_b16 a[8:9], v10 offset:80
    ds_read_b64_tr_b16 a[10:11], v10 offset:3920
    buffer_load_dwordx4 v2, s[28:31], s44 offen offset:1024 lds
    v_mfma_f32_16x16x32_bf16 v[84:87], a[52:55], a[80:83], v[84:87]
    ds_read_b64_tr_b16 a[12:13], v10 offset:120
    ds_read_b64_tr_b16 a[14:15], v10 offset:3960
    v_mfma_f32_16x16x32_bf16 v[96:99], a[52:55], a[84:87], v[96:99]
    ds_read_b64_tr_b16 a[16:17], v11 offset:0
    ds_read_b64_tr_b16 a[18:19], v11 offset:3840
    v_mfma_f32_16x16x32_bf16 v[56:59], a[56:59], a[76:79], v[56:59]
    ds_read_b64_tr_b16 a[20:21], v12 offset:160
    buffer_load_dwordx4 v3, s[28:31], s44 offen offset:2048 lds
    s_add_u32 m0, m0, 3072
    v_mfma_f32_16x16x32_bf16 v[88:91], a[56:59], a[80:83], v[88:91]
    ds_read_b64_tr_b16 a[22:23], v12 offset:4000
    ds_read_b64_tr_b16 a[24:25], v13 offset:192
    v_mfma_f32_16x16x32_bf16 v[60:63], a[60:63], a[76:79], v[60:63]
    ds_read_b64_tr_b16 a[26:27], v13 offset:4032
    ds_read_b64_tr_b16 a[28:29], v14 offset:224
    v_mfma_f32_16x16x32_bf16 v[92:95], a[60:63], a[80:83], v[92:95]
    ds_read_b64_tr_b16 a[30:31], v14 offset:4064
    s_sub_u32 s51, s51, 1
    s_branch K1Q0_loop
K1Q0_last:
    v_mfma_f32_16x16x32_bf16 v[44:47], a[44:47], a[76:79], v[44:47]
    ds_write_b64 v134, v[132:133] offset:320
    ds_write_b64 v134, v[132:133] offset:5696
    ds_write_b64 v135, v[132:133] offset:320
    v_cvt_pk_bf16_f32 v100, v32, v33
    v_mfma_f32_16x16x32_bf16 v[76:79], a[44:47], a[80:83], v[76:79]
    v_cvt_pk_bf16_f32 v101, v34, v35
    v_cvt_pk_bf16_f32 v104, v64, v65
    v_cvt_pk_bf16_f32 v105, v66, v67
    v_cvt_pk_bf16_f32 v108, v36, v37
    v_mfma_f32_16x16x32_bf16 v[48:51], a[48:51], a[76:79], v[48:51]
    v_cvt_pk_bf16_f32 v109, v38, v39
    v_cvt_pk_bf16_f32 v112, v68, v69
    v_cvt_pk_bf16_f32 v113, v70, v71
    v_cvt_pk_bf16_f32 v40, v40, v41
    v_mfma_f32_16x16x32_bf16 v[80:83], a[48:51], a[80:83], v[80:83]
    v_cvt_pk_bf16_f32 v41, v42, v43
    v_cvt_pk_bf16_f32 v72, v72, v73
    v_cvt_pk_bf16_f32 v73, v74, v75
    v_cvt_pk_bf16_f32 v44, v44, v45
    v_mfma_f32_16x16x32_bf16 v[52:55], a[52:55], a[76:79], v[52:55]
    v_cvt_pk_bf16_f32 v45, v46, v47
    v_cvt_pk_bf16_f32 v76, v76, v77
    v_cvt_pk_bf16_f32 v77, v78, v79
    v_cvt_pk_bf16_f32 v48, v48, v49
    v_mfma_f32_16x16x32_bf16 v[84:87], a[52:55], a[80:83], v[84:87]
    v_cvt_pk_bf16_f32 v49, v50, v51
    v_cvt_pk_bf16_f32 v80, v80, v81
    v_cvt_pk_bf16_f32 v81, v82, v83
    v_cndmask_b32 v42, 0, v48, s[76:77]
    v_mfma_f32_16x16x32_bf16 v[96:99], a[52:55], a[84:87], v[96:99]
    v_cndmask_b32 v43, 0, v49, s[76:77]
    ds_write_b128 v130, v[40:43] offset:0
    v_cndmask_b32 v74, 0, v80, s[76:77]
    v_cndmask_b32 v75, 0, v81, s[76:77]
    v_mfma_f32_16x16x32_bf16 v[56:59], a[56:59], a[76:79], v[56:59]
    ds_write_b128 v130, v[72:75] offset:1024
    v_cndmask_b32 v46, 0, v48, s[78:79]
    v_cndmask_b32 v47, 0, v49, s[78:79]
    ds_write_b128 v130, v[44:47] offset:2048
    v_mfma_f32_16x16x32_bf16 v[88:91], a[56:59], a[80:83], v[88:91]
    v_cndmask_b32 v78, 0, v80, s[78:79]
    v_cndmask_b32 v79, 0, v81, s[78:79]
    ds_write_b128 v130, v[76:79] offset:3072
    v_cvt_pk_bf16_f32 v52, v52, v53
    v_mfma_f32_16x16x32_bf16 v[60:63], a[60:63], a[76:79], v[60:63]
    v_cvt_pk_bf16_f32 v53, v54, v55
    ds_write_b64 v121, v[52:53] offset:0
    v_cvt_pk_bf16_f32 v84, v84, v85
    v_cvt_pk_bf16_f32 v85, v86, v87
    v_mfma_f32_16x16x32_bf16 v[92:95], a[60:63], a[80:83], v[92:95]
    ds_write_b64 v121, v[84:85] offset:5376
    v_cvt_pk_bf16_f32 v96, v96, v97
    v_cvt_pk_bf16_f32 v97, v98, v99
    ds_write_b64 v127, v[96:97] offset:0
    s_nop 7
    v_cvt_pk_bf16_f32 v56, v56, v57
    v_cvt_pk_bf16_f32 v57, v58, v59
    ds_write_b64 v122, v[56:57] offset:32
    v_cvt_pk_bf16_f32 v88, v88, v89
    v_cvt_pk_bf16_f32 v89, v90, v91
    ds_write_b64 v122, v[88:89] offset:5408
    v_cvt_pk_bf16_f32 v60, v60, v61
    v_cvt_pk_bf16_f32 v61, v62, v63
    ds_write_b64 v123, v[60:61] offset:64
    v_cvt_pk_bf16_f32 v92, v92, v93
    v_cvt_pk_bf16_f32 v93, v94, v95
    ds_write_b64 v123, v[92:93] offset:5440
    v_cndmask_b32 v102, 0, v48, s[72:73]
    v_cndmask_b32 v103, 0, v49, s[72:73]
    v_cndmask_b32 v106, 0, v80, s[72:73]
    v_cndmask_b32 v107, 0, v81, s[72:73]
    v_cndmask_b32 v110, 0, v48, s[74:75]
    v_cndmask_b32 v111, 0, v49, s[74:75]
    v_cndmask_b32 v114, 0, v80, s[74:75]
    v_cndmask_b32 v115, 0, v81, s[74:75]
    s_branch K1Q_attn
K1Q_n1:
    s_mov_b32 s52, 0
    s_mov_b32 s53, 0
    s_mov_b32 s54, 0
    s_mov_b32 s55, 0
    s_mov_b32 s56, 0
    s_cmp_eq_u32 s20, 1
    s_cselect_b32 s52, 64, s52
    s_cselect_b32 s53, 64, s53
    s_cselect_b32 s54, -64, s54
    s_cmp_eq_u32 s20, 2
    s_cselect_b32 s52, 128, s52
    s_cselect_b32 s53, 128, s53
    s_cselect_b32 s55, -128, s55
    s_cmp_eq_u32 s20, 3
    s_cselect_b32 s52, 192, s52
    s_cselect_b32 s56, -192, s56
    v_add_u32 v10, s52, v27
    v_add_u32 v11, s53, v27
    v_add_u32 v12, s54, v27
    v_add_u32 v13, s55, v27
    v_add_u32 v14, s56, v27
    v_mov_b32 v32, 0
    v_mov_b32 v33, 0
    v_mov_b32 v34, 0
    v_mov_b32 v35, 0
    v_mov_b32 v36, 0
    v_mov_b32 v37, 0
    v_mov_b32 v38, 0
    v_mov_b32 v39, 0
    v_mov_b32 v40, 0
    v_mov_b32 v41, 0
    v_mov_b32 v42, 0
    v_mov_b32 v43, 0
    v_mov_b32 v44, 0
    v_mov_b32 v45, 0
    v_mov_b32 v46, 0
    v_mov_b32 v47, 0
    v_mov_b32 v48, 0
    v_mov_b32 v49, 0
    v_mov_b32 v50, 0
    v_mov_b32 v51, 0
    v_mov_b32 v52, 0
    v_mov_b32 v53, 0
    v_mov_b32 v54, 0
    v_mov_b32 v55, 0
    v_mov_b32 v56, 0
    v_mov_b32 v57, 0
    v_mov_b32 v58, 0
    v_mov_b32 v59, 0
    v_mov_b32 v60, 0
    v_mov_b32 v61, 0
    v_mov_b32 v62, 0
    v_mov_b32 v63, 0
    v_mov_b32 v64, 0
    v_mov_b32 v65, 0
    v_mov_b32 v66, 0
    v_mov_b32 v67, 0
    v_mov_b32 v68, 0
    v_mov_b32 v69, 0
    v_mov_b32 v70, 0
    v_mov_b32 v71, 0
    v_mov_b32 v72, 0
    v_mov_b32 v73, 0
    v_mov_b32 v74, 0
    v_mov_b32 v75, 0
    v_mov_b32 v76, 0
    v_mov_b32 v77, 0
    v_mov_b32 v78, 0
    v_mov_b32 v79, 0
    v_mov_b32 v80, 0
    v_mov_b32 v81, 0
    v_mov_b32 v82, 0
    v_mov_b32 v83, 0
    v_mov_b32 v84, 0
    v_mov_b32 v85, 0
    v_mov_b32 v86, 0
    v_mov_b32 v87, 0
    v_mov_b32 v88, 0
    v_mov_b32 v89, 0
    v_mov_b32 v90, 0
    v_mov_b32 v91, 0
    v_mov_b32 v92, 0
    v_mov_b32 v93, 0
    v_mov_b32 v94, 0
    v_mov_b32 v95, 0
    s_nop 0
    buffer_load_dwordx4 v1, s[28:31], s44 offen offset:0 lds
    buffer_load_dwordx4 v2, s[28:31], s44 offen offset:1024 lds
    buffer_load_dwordx4 v3, s[28:31], s44 offen offset:2048 lds
    s_add_u32 m0, m0, 3072
    s_nop 0
    buffer_load_dwordx4 v4, s[28:31], s44 offen offset:0 lds
    buffer_load_dwordx4 v5, s[28:31], s44 offen offset:1024 lds
    buffer_load_dwordx4 v6, s[28:31], s44 offen offset:2048 lds
    s_add_u32 s44, s44, s50
    s_cmp_eq_u32 s44, s45
    s_cselect_b32 s44, 0, s44
    s_add_u32 s49, s49, 49152
    s_cmp_eq_u32 s49, s48
    s_cselect_b32 s49, s39, s49
    s_mov_b32 m0, s49
    s_add_u32 s32, s10, 0
    s_addc_u32 s33, s11, 0
    s_mov_b32 s34, 9699328
    s_mov_b32 s35, 0x20000
    s_lshl_b32 s60, s22, 3
    s_lshl_b32 s61, s20, 1
    s_add_u32 s60, s60, s61
    s_lshr_b32 s61, s60, 2
    s_mul_i32 s61, s61, 296
    s_and_b32 s60, s60, 3
    s_add_u32 s60, s60, s61
    s_lshl_b32 s60, s60, 10
    s_lshl_b32 s62, s20, 5
    s_add_u32 s62, s62, 16
    v_add_u32 v120, s62, v20
    v_mul_u32_u24 v120, 336, v120
    v_lshl_add_u32 v120, v21, 3, v120
    v_mul_u32_u24 v126, 336, v20
    v_lshl_add_u32 v126, v21, 3, v126
    v_add_u32 v121, s52, v120
    v_add_u32 v122, s53, v120
    v_add_u32 v123, s54, v120
    v_add_u32 v124, s55, v120
    v_add_u32 v125, s56, v120
    v_add_u32 v127, s52, v126
    v_add_u32 v128, s53, v126
    v_lshlrev_b32 v130, 4, v9
    s_lshl_b32 s62, s20, 12
    s_add_u32 s62, s62, 49152
    v_add_u32 v130, s62, v130
    v_and_b32 v140, 1, v20
    v_lshl_add_u32 v141, v21, 2, v140
    v_cmp_eq_u32 s[84:85], 1, v140
    v_cmp_le_u32 s[86:87], v141, v20
    v_add_u32 v141, 2, v141
    v_cmp_le_u32 s[88:89], v141, v20
    v_mov_b32 v140, 0xffff
    v_mov_b32 v141, 0xffff0000
    v_cndmask_b32 v140, v140, v141, s[84:85]
    v_cndmask_b32 v142, 0, v140, s[86:87]
    v_cndmask_b32 v143, v140, 0, s[86:87]
    v_cndmask_b32 v144, 0, v140, s[88:89]
    v_cndmask_b32 v145, v140, 0, s[88:89]
    s_or_b32 s62, s22, s20
    s_cmp_eq_u32 s62, 0
    s_cselect_b32 s62, 0xf149f2ca, 0
    v_mov_b32 v140, s62
    v_cndmask_b32 v146, v140, 0, s[86:87]
    v_cndmask_b32 v147, v140, 0, s[88:89]
    s_lshl_b32 s62, s20, 5
    s_mul_i32 s63, s47, 80
    v_add_u32 v148, s62, v20
    v_mul_u32_u24 v148, 336, v148
    v_add_u32 v148, s63, v148
    v_add_u32 v149, 32, v148
    v_lshl_add_u32 v148, v21, 3, v148
    v_lshrrev_b32 v150, 2, v9
    v_add_u32 v150, s62, v150
    v_mul_u32_u24 v150, 336, v150
    v_and_b32 v151, 3, v9
    s_lshl_b32 s66, s47, 1
    s_add_u32 s67, s66, 0
    v_cmp_eq_u32 vcc, s67, v151
    s_add_u32 s67, s63, 192
    v_mov_b32 v140, s67
    v_mov_b32 v141, 320
    v_cndmask_b32 v140, v141, v140, vcc
    v_add_u32 v152, v150, v140
    s_add_u32 s67, s66, 1
    v_cmp_eq_u32 vcc, s67, v151
    s_add_u32 s67, s63, 232
    v_mov_b32 v140, s67
    v_mov_b32 v141, 320
    v_cndmask_b32 v140, v141, v140, vcc
    v_add_u32 v153, v150, v140
    v_lshl_add_u32 v150, v151, 3, v150
    v_add_u32 v150, s63, v150
    s_mul_i32 s62, s23, 20
    s_mul_i32 s63, s47, 10
    s_add_u32 s63, s63, s62
    s_add_u32 s67, s63, 0
    v_add_u32 v151, s67, v21
    v_lshrrev_b32 v140, 3, v151
    v_lshlrev_b32 v140, 12, v140
    v_and_b32 v141, 3, v151
    v_lshl_add_u32 v140, v141, 8, v140
    v_bfe_u32 v141, v151, 2, 1
    v_lshl_add_u32 v140, v141, 3, v140
    v_lshl_add_u32 v154, v20, 4, v140
    s_add_u32 s67, s63, 5
    v_add_u32 v151, s67, v21
    v_lshrrev_b32 v140, 3, v151
    v_lshlrev_b32 v140, 12, v140
    v_and_b32 v141, 3, v151
    v_lshl_add_u32 v140, v141, 8, v140
    v_bfe_u32 v141, v151, 2, 1
    v_lshl_add_u32 v140, v141, 3, v140
    v_lshl_add_u32 v155, v20, 4, v140
    v_mul_u32_u24 v151, 5, v21
    s_add_u32 s63, s62, 4
    v_add_u32 v151, s63, v151
    v_lshrrev_b32 v140, 3, v151
    v_lshlrev_b32 v140, 12, v140
    v_and_b32 v141, 3, v151
    v_lshl_add_u32 v140, v141, 8, v140
    v_bfe_u32 v141, v151, 2, 1
    v_lshl_add_u32 v140, v141, 3, v140
    v_lshl_add_u32 v156, v20, 4, v140
    s_mov_b32 s80, 0x3ea52b5c
    s_waitcnt vmcnt(6)
    s_barrier
    ds_read_b128 a[64:67], v16 offset:0
    ds_read_b128 a[68:71], v16 offset:2048
    ds_read_b128 a[72:75], v18
    ds_read_b64_tr_b16 a[0:1], v10 offset:256
    ds_read_b64_tr_b16 a[2:3], v10 offset:4096
    ds_read_b64_tr_b16 a[4:5], v11 offset:288
    ds_read_b64_tr_b16 a[6:7], v11 offset:4128
    ds_read_b64_tr_b16 a[8:9], v12 offset:320
    ds_read_b64_tr_b16 a[10:11], v12 offset:4160
    ds_read_b64_tr_b16 a[12:13], v12 offset:352
    ds_read_b64_tr_b16 a[14:15], v12 offset:4192
    ds_read_b64_tr_b16 a[16:17], v13 offset:384
    ds_read_b64_tr_b16 a[18:19], v13 offset:4224
    ds_read_b64_tr_b16 a[20:21], v13 offset:416
    ds_read_b64_tr_b16 a[22:23], v13 offset:4256
    ds_read_b64_tr_b16 a[24:25], v14 offset:448
    ds_read_b64_tr_b16 a[26:27], v14 offset:4288
    buffer_load_dwordx4 v1, s[28:31], s44 offen offset:0 lds
    buffer_load_dwordx4 v2, s[28:31], s44 offen offset:1024 lds
    buffer_load_dwordx4 v3, s[28:31], s44 offen offset:2048 lds
    s_add_u32 m0, m0, 3072
K1Q1_loop:
    s_waitcnt lgkmcnt(10)
    v_mfma_f32_16x16x32_bf16 v[32:35], a[0:3], a[64:67], v[32:35]
    ds_read_b128 a[76:79], v17 offset:0
    ds_read_b128 a[80:83], v17 offset:2048
    v_mfma_f32_16x16x32_bf16 v[60:63], a[0:3], a[68:71], v[60:63]
    ds_read_b128 a[84:87], v19
    v_mfma_f32_16x16x32_bf16 v[88:91], a[0:3], a[72:75], v[88:91]
    ds_read_b64_tr_b16 a[32:33], v10 offset:15616
    buffer_load_dwordx4 v4, s[28:31], s44 offen offset:0 lds
    v_mfma_f32_16x16x32_bf16 v[36:39], a[4:7], a[64:67], v[36:39]
    ds_read_b64_tr_b16 a[34:35], v10 offset:19456
    v_mfma_f32_16x16x32_bf16 v[64:67], a[4:7], a[68:71], v[64:67]
    ds_read_b64_tr_b16 a[36:37], v11 offset:15648
    v_mfma_f32_16x16x32_bf16 v[92:95], a[4:7], a[72:75], v[92:95]
    ds_read_b64_tr_b16 a[38:39], v11 offset:19488
    s_waitcnt lgkmcnt(13)
    v_mfma_f32_16x16x32_bf16 v[40:43], a[8:11], a[64:67], v[40:43]
    ds_read_b64_tr_b16 a[40:41], v12 offset:15680
    buffer_load_dwordx4 v5, s[28:31], s44 offen offset:1024 lds
    v_mfma_f32_16x16x32_bf16 v[68:71], a[8:11], a[68:71], v[68:71]
    ds_read_b64_tr_b16 a[42:43], v12 offset:19520
    v_mfma_f32_16x16x32_bf16 v[44:47], a[12:15], a[64:67], v[44:47]
    ds_read_b64_tr_b16 a[44:45], v12 offset:15712
    v_mfma_f32_16x16x32_bf16 v[72:75], a[12:15], a[68:71], v[72:75]
    ds_read_b64_tr_b16 a[46:47], v12 offset:19552
    s_waitcnt lgkmcnt(13)
    v_mfma_f32_16x16x32_bf16 v[48:51], a[16:19], a[64:67], v[48:51]
    ds_read_b64_tr_b16 a[48:49], v13 offset:15744
    v_mfma_f32_16x16x32_bf16 v[76:79], a[16:19], a[68:71], v[76:79]
    ds_read_b64_tr_b16 a[50:51], v13 offset:19584
    buffer_load_dwordx4 v6, s[28:31], s44 offen offset:2048 lds
    v_mfma_f32_16x16x32_bf16 v[52:55], a[20:23], a[64:67], v[52:55]
    ds_read_b64_tr_b16 a[52:53], v13 offset:15776
    v_mfma_f32_16x16x32_bf16 v[80:83], a[20:23], a[68:71], v[80:83]
    ds_read_b64_tr_b16 a[54:55], v13 offset:19616
    s_waitcnt lgkmcnt(13)
    v_mfma_f32_16x16x32_bf16 v[56:59], a[24:27], a[64:67], v[56:59]
    ds_read_b64_tr_b16 a[56:57], v14 offset:15808
    v_mfma_f32_16x16x32_bf16 v[84:87], a[24:27], a[68:71], v[84:87]
    ds_read_b64_tr_b16 a[58:59], v14 offset:19648
    s_waitcnt lgkmcnt(10)
    v_mfma_f32_16x16x32_bf16 v[32:35], a[32:35], a[76:79], v[32:35]
    s_add_u32 s44, s44, s50
    s_cmp_eq_u32 s44, s45
    s_cselect_b32 s44, 0, s44
    s_add_u32 s49, s49, 49152
    s_cmp_eq_u32 s49, s48
    s_cselect_b32 s49, s39, s49
    s_cmp_eq_u32 s49, s46
    s_cselect_b32 s57, -98304, s59
    v_mfma_f32_16x16x32_bf16 v[60:63], a[32:35], a[80:83], v[60:63]
    s_mov_b32 m0, s49
    s_cmp_le_u32 s51, 3
    s_cbranch_scc1 K1Q1_tail
K1Q1_tailed:
    v_add_u32 v10, s57, v10
    v_mfma_f32_16x16x32_bf16 v[88:91], a[32:35], a[84:87], v[88:91]
    v_add_u32 v11, s57, v11
    v_add_u32 v12, s57, v12
    v_mfma_f32_16x16x32_bf16 v[36:39], a[36:39], a[76:79], v[36:39]
    v_add_u32 v13, s57, v13
    v_add_u32 v14, s57, v14
    v_mfma_f32_16x16x32_bf16 v[64:67], a[36:39], a[80:83], v[64:67]
    v_add_u32 v16, s57, v16
    v_add_u32 v17, s57, v17
    v_mfma_f32_16x16x32_bf16 v[92:95], a[36:39], a[84:87], v[92:95]
    v_add_u32 v18, s57, v18
    v_add_u32 v19, s57, v19
K1Q1_mid:
    s_waitcnt vmcnt(6) lgkmcnt(0)
    s_cmp_eq_u32 s51, 1
    s_barrier
    s_cbranch_scc1 K1Q1_last
    v_mfma_f32_16x16x32_bf16 v[40:43], a[40:43], a[76:79], v[40:43]
    ds_read_b128 a[64:67], v16 offset:0
    ds_read_b128 a[68:71], v16 offset:2048
    v_mfma_f32_16x16x32_bf16 v[68:71], a[40:43], a[80:83], v[68:71]
    ds_read_b128 a[72:75], v18
    ds_read_b64_tr_b16 a[0:1], v10 offset:256
    buffer_load_dwordx4 v1, s[28:31], s44 offen offset:0 lds
    v_mfma_f32_16x16x32_bf16 v[44:47], a[44:47], a[76:79], v[44:47]
    ds_read_b64_tr_b16 a[2:3], v10 offset:4096
    ds_read_b64_tr_b16 a[4:5], v11 offset:288
    v_mfma_f32_16x16x32_bf16 v[72:75], a[44:47], a[80:83], v[72:75]
    ds_read_b64_tr_b16 a[6:7], v11 offset:4128
    v_mfma_f32_16x16x32_bf16 v[48:51], a[48:51], a[76:79], v[48:51]
    ds_read_b64_tr_b16 a[8:9], v12 offset:320
    ds_read_b64_tr_b16 a[10:11], v12 offset:4160
    buffer_load_dwordx4 v2, s[28:31], s44 offen offset:1024 lds
    v_mfma_f32_16x16x32_bf16 v[76:79], a[48:51], a[80:83], v[76:79]
    ds_read_b64_tr_b16 a[12:13], v12 offset:352
    ds_read_b64_tr_b16 a[14:15], v12 offset:4192
    v_mfma_f32_16x16x32_bf16 v[52:55], a[52:55], a[76:79], v[52:55]
    ds_read_b64_tr_b16 a[16:17], v13 offset:384
    v_mfma_f32_16x16x32_bf16 v[80:83], a[52:55], a[80:83], v[80:83]
    ds_read_b64_tr_b16 a[18:19], v13 offset:4224
    ds_read_b64_tr_b16 a[20:21], v13 offset:416
    buffer_load_dwordx4 v3, s[28:31], s44 offen offset:2048 lds
    s_add_u32 m0, m0, 3072
    v_mfma_f32_16x16x32_bf16 v[56:59], a[56:59], a[76:79], v[56:59]
    ds_read_b64_tr_b16 a[22:23], v13 offset:4256
    ds_read_b64_tr_b16 a[24:25], v14 offset:448
    v_mfma_f32_16x16x32_bf16 v[84:87], a[56:59], a[80:83], v[84:87]
    ds_read_b64_tr_b16 a[26:27], v14 offset:4288
    s_sub_u32 s51, s51, 1
    s_branch K1Q1_loop
K1Q1_last:
    v_mfma_f32_16x16x32_bf16 v[40:43], a[40:43], a[76:79], v[40:43]
    v_cvt_pk_bf16_f32 v32, v32, v33
    v_cvt_pk_bf16_f32 v33, v34, v35
    ds_write_b64 v121, v[32:33] offset:96
    v_cvt_pk_bf16_f32 v60, v60, v61
    v_mfma_f32_16x16x32_bf16 v[68:71], a[40:43], a[80:83], v[68:71]
    v_cvt_pk_bf16_f32 v61, v62, v63
    ds_write_b64 v121, v[60:61] offset:5472
    v_cvt_pk_bf16_f32 v88, v88, v89
    v_cvt_pk_bf16_f32 v89, v90, v91
    v_mfma_f32_16x16x32_bf16 v[44:47], a[44:47], a[76:79], v[44:47]
    ds_write_b64 v127, v[88:89] offset:96
    v_cvt_pk_bf16_f32 v36, v36, v37
    v_cvt_pk_bf16_f32 v37, v38, v39
    ds_write_b64 v122, v[36:37] offset:128
    v_mfma_f32_16x16x32_bf16 v[72:75], a[44:47], a[80:83], v[72:75]
    v_cvt_pk_bf16_f32 v64, v64, v65
    v_cvt_pk_bf16_f32 v65, v66, v67
    ds_write_b64 v122, v[64:65] offset:5504
    v_cvt_pk_bf16_f32 v92, v92, v93
    v_mfma_f32_16x16x32_bf16 v[48:51], a[48:51], a[76:79], v[48:51]
    v_cvt_pk_bf16_f32 v93, v94, v95
    ds_write_b64 v128, v[92:93] offset:128
    v_cvt_pk_bf16_f32 v40, v40, v41
    v_cvt_pk_bf16_f32 v41, v42, v43
    v_mfma_f32_16x16x32_bf16 v[76:79], a[48:51], a[80:83], v[76:79]
    ds_write_b64 v123, v[40:41] offset:160
    v_cvt_pk_bf16_f32 v68, v68, v69
    v_cvt_pk_bf16_f32 v69, v70, v71
    ds_write_b64 v123, v[68:69] offset:5536
    v_mfma_f32_16x16x32_bf16 v[52:55], a[52:55], a[76:79], v[52:55]
    v_cvt_pk_bf16_f32 v44, v44, v45
    v_cvt_pk_bf16_f32 v45, v46, v47
    ds_write_b64 v123, v[44:45] offset:192
    v_cvt_pk_bf16_f32 v72, v72, v73
    v_mfma_f32_16x16x32_bf16 v[80:83], a[52:55], a[80:83], v[80:83]
    v_cvt_pk_bf16_f32 v73, v74, v75
    ds_write_b64 v123, v[72:73] offset:5568
    v_cvt_pk_bf16_f32 v48, v48, v49
    v_cvt_pk_bf16_f32 v49, v50, v51
    v_mfma_f32_16x16x32_bf16 v[56:59], a[56:59], a[76:79], v[56:59]
    ds_write_b64 v124, v[48:49] offset:224
    v_cvt_pk_bf16_f32 v76, v76, v77
    v_cvt_pk_bf16_f32 v77, v78, v79
    ds_write_b64 v124, v[76:77] offset:5600
    v_mfma_f32_16x16x32_bf16 v[84:87], a[56:59], a[80:83], v[84:87]
    v_cvt_pk_bf16_f32 v52, v52, v53
    v_cvt_pk_bf16_f32 v53, v54, v55
    ds_write_b64 v124, v[52:53] offset:256
    v_cvt_pk_bf16_f32 v80, v80, v81
    s_nop 7
    v_cvt_pk_bf16_f32 v81, v82, v83
    ds_write_b64 v124, v[80:81] offset:5632
    v_cvt_pk_bf16_f32 v56, v56, v57
    v_cvt_pk_bf16_f32 v57, v58, v59
    ds_write_b64 v125, v[56:57] offset:288
    v_cvt_pk_bf16_f32 v84, v84, v85
    v_cvt_pk_bf16_f32 v85, v86, v87
    ds_write_b64 v125, v[84:85] offset:5664
K1Q_attn:
    s_waitcnt lgkmcnt(0)
    s_barrier
    s_cmp_eq_u32 s47, 0
    s_cbranch_scc1 K1Q_haveq
    ds_read_b128 v[100:103], v130 offset:0
    ds_read_b128 v[104:107], v130 offset:1024
    ds_read_b128 v[108:111], v130 offset:2048
    ds_read_b128 v[112:115], v130 offset:3072
K1Q_haveq:
    ds_read_b64 a[0:1], v148 offset:0
    ds_read_b64 a[2:3], v149 offset:0
    ds_read_b64 a[4:5], v148 offset:5376
    ds_read_b64 a[6:7], v149 offset:5376
    ds_read_b64 a[8:9], v148 offset:10752
    ds_read_b64 a[10:11], v149 offset:10752
    ds_read_b64 a[24:25], v148 offset:40
    ds_read_b64 a[26:27], v149 offset:40
    ds_read_b64 a[28:29], v148 offset:5416
    ds_read_b64 a[30:31], v149 offset:5416
    ds_read_b64 a[32:33], v148 offset:10792
    ds_read_b64 a[34:35], v149 offset:10792
    v_mov_b32 v64, 0
    v_mov_b32 v65, 0
    v_mov_b32 v66, 0
    v_mov_b32 v67, 0
    v_mov_b32 v68, 0
    v_mov_b32 v69, 0
    v_mov_b32 v70, 0
    v_mov_b32 v71, 0
    s_waitcnt lgkmcnt(0)
    v_mfma_f32_16x16x32_bf16 v[32:35], a[0:3], v[100:103], 0
    v_mfma_f32_16x16x32_bf16 v[36:39], a[4:7], v[100:103], 0
    v_mfma_f32_16x16x32_bf16 v[40:43], a[4:7], v[104:107], 0
    v_mfma_f32_16x16x32_bf16 v[44:47], a[8:11], v[104:107], 0
    v_mfma_f32_16x16x32_bf16 v[48:51], a[24:27], v[108:111], 0
    v_mfma_f32_16x16x32_bf16 v[52:55], a[28:31], v[108:111], 0
    v_mfma_f32_16x16x32_bf16 v[56:59], a[28:31], v[112:115], 0
    v_mfma_f32_16x16x32_bf16 v[60:63], a[32:35], v[112:115], 0
    ds_read_b64_tr_b16 a[12:13], v150 offset:160
    ds_read_b64_tr_b16 a[18:19], v152 offset:0
    ds_read_b64_tr_b16 a[14:15], v150 offset:5536
    ds_read_b64_tr_b16 a[20:21], v152 offset:5376
    ds_read_b64_tr_b16 a[16:17], v150 offset:10912
    ds_read_b64_tr_b16 a[22:23], v152 offset:10752
    ds_read_b64_tr_b16 a[36:37], v150 offset:200
    ds_read_b64_tr_b16 a[42:43], v153 offset:0
    ds_read_b64_tr_b16 a[38:39], v150 offset:5576
    ds_read_b64_tr_b16 a[44:45], v153 offset:5376
    ds_read_b64_tr_b16 a[40:41], v150 offset:10952
    ds_read_b64_tr_b16 a[46:47], v153 offset:10752
    v_cndmask_b32 v72, v36, v37, s[84:85]
    v_cndmask_b32 v73, v32, v33, s[84:85]
    v_cndmask_b32 v74, v38, v39, s[84:85]
    v_cndmask_b32 v75, v34, v35, s[84:85]
    v_cndmask_b32 v72, v73, v72, s[86:87]
    v_cndmask_b32 v74, v75, v74, s[88:89]
    v_fma_f32 v72, v72, s80, v146
    v_fma_f32 v74, v74, s80, v147
    v_max_f32 v73, v72, v74
    v_mov_b32 v75, v73
    v_cndmask_b32 v76, v44, v45, s[84:85]
    v_cndmask_b32 v77, v40, v41, s[84:85]
    v_cndmask_b32 v78, v46, v47, s[84:85]
    v_cndmask_b32 v79, v42, v43, s[84:85]
    v_cndmask_b32 v76, v77, v76, s[86:87]
    v_cndmask_b32 v78, v79, v78, s[88:89]
    v_mul_f32 v76, s80, v76
    v_mul_f32 v78, s80, v78
    v_max_f32 v77, v76, v78
    v_mov_b32 v79, v77
    v_cndmask_b32 v80, v52, v53, s[84:85]
    v_cndmask_b32 v81, v48, v49, s[84:85]
    v_cndmask_b32 v82, v54, v55, s[84:85]
    v_cndmask_b32 v83, v50, v51, s[84:85]
    v_cndmask_b32 v80, v81, v80, s[86:87]
    v_cndmask_b32 v82, v83, v82, s[88:89]
    v_fma_f32 v80, v80, s80, v146
    v_fma_f32 v82, v82, s80, v147
    v_max_f32 v81, v80, v82
    v_mov_b32 v83, v81
    v_cndmask_b32 v84, v60, v61, s[84:85]
    v_cndmask_b32 v85, v56, v57, s[84:85]
    v_cndmask_b32 v86, v62, v63, s[84:85]
    v_cndmask_b32 v87, v58, v59, s[84:85]
    v_cndmask_b32 v84, v85, v84, s[86:87]
    v_cndmask_b32 v86, v87, v86, s[88:89]
    v_mul_f32 v84, s80, v84
    v_mul_f32 v86, s80, v86
    v_max_f32 v85, v84, v86
    v_mov_b32 v87, v85
    s_nop 1
    v_permlane32_swap_b32 v73, v75
    v_permlane32_swap_b32 v77, v79
    v_permlane32_swap_b32 v81, v83
    v_permlane32_swap_b32 v85, v87
    v_max_f32 v73, v73, v75
    v_mov_b32 v75, v73
    v_max_f32 v77, v77, v79
    v_mov_b32 v79, v77
    v_max_f32 v81, v81, v83
    v_mov_b32 v83, v81
    v_max_f32 v85, v85, v87
    v_mov_b32 v87, v85
    s_nop 1
    v_permlane16_swap_b32 v73, v75
    v_permlane16_swap_b32 v77, v79
    v_permlane16_swap_b32 v81, v83
    v_permlane16_swap_b32 v85, v87
    v_max_f32 v73, v73, v75
    v_sub_f32 v72, v72, v73
    v_sub_f32 v74, v74, v73
    v_exp_f32 v72, v72
    v_exp_f32 v74, v74
    v_max_f32 v77, v77, v79
    v_sub_f32 v76, v76, v77
    v_sub_f32 v78, v78, v77
    v_exp_f32 v76, v76
    v_exp_f32 v78, v78
    v_max_f32 v81, v81, v83
    v_sub_f32 v80, v80, v81
    v_sub_f32 v82, v82, v81
    v_exp_f32 v80, v80
    v_exp_f32 v82, v82
    v_max_f32 v85, v85, v87
    v_sub_f32 v84, v84, v85
    v_sub_f32 v86, v86, v85
    v_exp_f32 v84, v84
    v_exp_f32 v86, v86
    s_nop 0
    v_add_f32 v73, v72, v74
    v_mov_b32 v75, v73
    v_add_f32 v77, v76, v78
    v_mov_b32 v79, v77
    v_add_f32 v81, v80, v82
    v_mov_b32 v83, v81
    v_add_f32 v85, v84, v86
    v_mov_b32 v87, v85
    s_nop 1
    v_permlane32_swap_b32 v73, v75
    v_permlane32_swap_b32 v77, v79
    v_permlane32_swap_b32 v81, v83
    v_permlane32_swap_b32 v85, v87
    v_add_f32 v73, v73, v75
    v_mov_b32 v75, v73
    v_add_f32 v77, v77, v79
    v_mov_b32 v79, v77
    v_add_f32 v81, v81, v83
    v_mov_b32 v83, v81
    v_add_f32 v85, v85, v87
    v_mov_b32 v87, v85
    s_nop 1
    v_permlane16_swap_b32 v73, v75
    v_permlane16_swap_b32 v77, v79
    v_permlane16_swap_b32 v81, v83
    v_permlane16_swap_b32 v85, v87
    v_add_f32 v73, v73, v75
    v_rcp_f32 v73, v73
    v_add_f32 v77, v77, v79
    v_rcp_f32 v77, v77
    v_add_f32 v81, v81, v83
    v_rcp_f32 v81, v81
    v_add_f32 v85, v85, v87
    v_rcp_f32 v85, v85
    s_nop 0
    v_mul_f32 v72, v72, v73
    v_mul_f32 v74, v74, v73
    v_cvt_pk_bf16_f32 v72, v72, v72
    v_cvt_pk_bf16_f32 v74, v74, v74
    v_and_b32 v116, v72, v143
    v_and_b32 v117, v74, v145
    v_and_b32 v118, v72, v142
    v_and_b32 v119, v74, v144
    v_mul_f32 v76, v76, v77
    v_mul_f32 v78, v78, v77
    v_cvt_pk_bf16_f32 v76, v76, v76
    v_cvt_pk_bf16_f32 v78, v78, v78
    v_and_b32 v120, v76, v143
    v_and_b32 v121, v78, v145
    v_and_b32 v122, v76, v142
    v_and_b32 v123, v78, v144
    v_mul_f32 v80, v80, v81
    v_mul_f32 v82, v82, v81
    v_cvt_pk_bf16_f32 v80, v80, v80
    v_cvt_pk_bf16_f32 v82, v82, v82
    v_and_b32 v124, v80, v143
    v_and_b32 v125, v82, v145
    v_and_b32 v126, v80, v142
    v_and_b32 v127, v82, v144
    v_mul_f32 v84, v84, v85
    v_mul_f32 v86, v86, v85
    v_cvt_pk_bf16_f32 v84, v84, v84
    v_cvt_pk_bf16_f32 v86, v86, v86
    v_and_b32 v128, v84, v143
    v_and_b32 v129, v86, v145
    v_and_b32 v130, v84, v142
    v_and_b32 v131, v86, v144
    s_waitcnt lgkmcnt(0)
    s_nop 0
    v_mfma_f32_16x16x32_bf16 v[32:35], a[12:15], v[116:119], 0
    v_mfma_f32_16x16x32_bf16 v[40:43], a[14:17], v[120:123], 0
    v_mfma_f32_16x16x32_bf16 v[48:51], a[36:39], v[124:127], 0
    v_mfma_f32_16x16x32_bf16 v[56:59], a[38:41], v[128:131], 0
    v_mfma_f32_16x16x32_bf16 v[64:67], a[18:21], v[116:119], v[64:67]
    v_mfma_f32_16x16x32_bf16 v[68:71], a[20:23], v[120:123], v[68:71]
    v_mfma_f32_16x16x32_bf16 v[64:67], a[42:45], v[124:127], v[64:67]
    v_mfma_f32_16x16x32_bf16 v[68:71], a[44:47], v[128:131], v[68:71]
    s_nop 3
    v_cvt_pk_bf16_f32 v88, v32, v33
    v_cvt_pk_bf16_f32 v89, v34, v35
    buffer_store_dwordx2 v[88:89], v154, s[32:35], s60 offen offset:0
    v_cvt_pk_bf16_f32 v90, v40, v41
    v_cvt_pk_bf16_f32 v91, v42, v43
    buffer_store_dwordx2 v[90:91], v154, s[32:35], s60 offen offset:1024
    v_cvt_pk_bf16_f32 v92, v48, v49
    v_cvt_pk_bf16_f32 v93, v50, v51
    buffer_store_dwordx2 v[92:93], v155, s[32:35], s60 offen offset:0
    v_cvt_pk_bf16_f32 v94, v56, v57
    v_cvt_pk_bf16_f32 v95, v58, v59
    buffer_store_dwordx2 v[94:95], v155, s[32:35], s60 offen offset:1024
    v_cvt_pk_bf16_f32 v72, v64, v65
    v_cvt_pk_bf16_f32 v73, v66, v67
    v_cvt_pk_bf16_f32 v76, v68, v69
    v_cvt_pk_bf16_f32 v77, v70, v71
    s_cmp_eq_u32 s47, 0
    s_cselect_b32 exec_lo, -1, 0
    s_cselect_b32 exec_hi, 0, -1
    buffer_store_dwordx2 v[72:73], v156, s[32:35], s60 offen offset:0
    buffer_store_dwordx2 v[76:77], v156, s[32:35], s60 offen offset:1024
    s_mov_b64 exec, -1
    s_endpgm
K1Q0_tail:
    s_mov_b32 s30, 0
    s_mov_b32 m0, 0x30000
    s_branch K1Q0_tailed
K1Q1_tail:
    s_mov_b32 s30, 0
    s_mov_b32 m0, 0x30000
    s_branch K1Q1_tailed
K1_ffn:
    s_add_u32 s48, s39, 147456
    s_add_u32 s46, s39, 98304
    s_mov_b32 s49, s39
    s_mul_i32 s42, s23, 7
    s_cmp_eq_u32 s23, 7
    s_cselect_b32 s42, 48, s42
    s_cmp_lt_u32 s23, 6
    s_cselect_b32 s43, 28, 24
    s_lshl_b32 s37, s42, 6
    s_cmp_ge_u32 s41, 5
    s_cbranch_scc1 K1F_aload
    s_mov_b32 s50, 221184
    s_mov_b32 s30, 2211840
    s_mul_i32 s38, s41, 384
    v_mov_b32 v40, 0x7f000000
    v_add_u32 v36, s38, v9
    v_add_u32 v32, 0, v36
    v_mul_u32_u24 v33, 0x889, v32
    v_lshrrev_b32 v33, 16, v33
    v_mul_u32_u24 v34, 30, v33
    v_sub_u32 v32, v32, v34
    v_and_b32 v34, 0x33, v33
    v_and_b32 v35, 4, v33
    v_lshl_or_b32 v34, v35, 1, v34
    v_and_b32 v35, 8, v33
    v_lshrrev_b32 v35, 1, v35
    v_or_b32 v33, v34, v35
    v_mul_u32_u24 v33, 3456, v33
    v_lshl_add_u32 v33, v32, 4, v33
    v_add_u32 v33, s37, v33
    v_cmp_gt_u32 vcc, s43, v32
    v_subrev_u32 v33, 0, v33
    s_nop 0
    v_cndmask_b32 v1, v40, v33, vcc
    v_add_u32 v32, 64, v36
    v_mul_u32_u24 v33, 0x889, v32
    v_lshrrev_b32 v33, 16, v33
    v_mul_u32_u24 v34, 30, v33
    v_sub_u32 v32, v32, v34
    v_and_b32 v34, 0x33, v33
    v_and_b32 v35, 4, v33
    v_lshl_or_b32 v34, v35, 1, v34
    v_and_b32 v35, 8, v33
    v_lshrrev_b32 v35, 1, v35
    v_or_b32 v33, v34, v35
    v_mul_u32_u24 v33, 3456, v33
    v_lshl_add_u32 v33, v32, 4, v33
    v_add_u32 v33, s37, v33
    v_cmp_gt_u32 vcc, s43, v32
    v_subrev_u32 v33, 1024, v33
    s_nop 0
    v_cndmask_b32 v2, v40, v33, vcc
    v_add_u32 v32, 128, v36
    v_mul_u32_u24 v33, 0x889, v32
    v_lshrrev_b32 v33, 16, v33
    v_mul_u32_u24 v34, 30, v33
    v_sub_u32 v32, v32, v34
    v_and_b32 v34, 0x33, v33
    v_and_b32 v35, 4, v33
    v_lshl_or_b32 v34, v35, 1, v34
    v_and_b32 v35, 8, v33
    v_lshrrev_b32 v35, 1, v35
    v_or_b32 v33, v34, v35
    v_mul_u32_u24 v33, 3456, v33
    v_lshl_add_u32 v33, v32, 4, v33
    v_add_u32 v33, s37, v33
    v_cmp_gt_u32 vcc, s43, v32
    v_subrev_u32 v33, 2048, v33
    s_nop 0
    v_cndmask_b32 v3, v40, v33, vcc
    v_add_u32 v32, 192, v36
    v_mul_u32_u24 v33, 0x889, v32
    v_lshrrev_b32 v33, 16, v33
    v_mul_u32_u24 v34, 30, v33
    v_sub_u32 v32, v32, v34
    v_and_b32 v34, 0x33, v33
    v_and_b32 v35, 4, v33
    v_lshl_or_b32 v34, v35, 1, v34
    v_and_b32 v35, 8, v33
    v_lshrrev_b32 v35, 1, v35
    v_or_b32 v33, v34, v35
    v_mul_u32_u24 v33, 3456, v33
    v_lshl_add_u32 v33, v32, 4, v33
    v_add_u32 v33, s37, v33
    v_cmp_gt_u32 vcc, s43, v32
    v_subrev_u32 v33, 0, v33
    s_nop 0
    v_cndmask_b32 v4, v40, v33, vcc
    v_add_u32 v32, 256, v36
    v_mul_u32_u24 v33, 0x889, v32
    v_lshrrev_b32 v33, 16, v33
    v_mul_u32_u24 v34, 30, v33
    v_sub_u32 v32, v32, v34
    v_and_b32 v34, 0x33, v33
    v_and_b32 v35, 4, v33
    v_lshl_or_b32 v34, v35, 1, v34
    v_and_b32 v35, 8, v33
    v_lshrrev_b32 v35, 1, v35
    v_or_b32 v33, v34, v35
    v_mul_u32_u24 v33, 3456, v33
    v_lshl_add_u32 v33, v32, 4, v33
    v_add_u32 v33, s37, v33
    v_cmp_gt_u32 vcc, s43, v32
    v_subrev_u32 v33, 1024, v33
    s_nop 0
    v_cndmask_b32 v5, v40, v33, vcc
    v_add_u32 v32, 320, v36
    v_mul_u32_u24 v33, 0x889, v32
    v_lshrrev_b32 v33, 16, v33
    v_mul_u32_u24 v34, 30, v33
    v_sub_u32 v32, v32, v34
    v_and_b32 v34, 0x33, v33
    v_and_b32 v35, 4, v33
    v_lshl_or_b32 v34, v35, 1, v34
    v_and_b32 v35, 8, v33
    v_lshrrev_b32 v35, 1, v35
    v_or_b32 v33, v34, v35
    v_mul_u32_u24 v33, 3456, v33
    v_lshl_add_u32 v33, v32, 4, v33
    v_add_u32 v33, s37, v33
    v_cmp_gt_u32 vcc, s43, v32
    v_subrev_u32 v33, 2048, v33
    s_nop 0
    v_cndmask_b32 v6, v40, v33, vcc
    s_waitcnt lgkmcnt(0)
    s_mov_b32 s28, s12
    s_mov_b32 s29, s13
    s_branch K1F_loads
K1F_aload:
    s_movk_i32 s50, 128
    s_mov_b32 s30, 2621440
    v_lshrrev_b32 v28, 3, v9
    v_and_b32 v29, 7, v9
    v_lshrrev_b32 v30, 1, v28
    v_xor_b32 v30, v29, v30
    v_xor_b32 v31, 4, v30
    s_sub_u32 s38, s41, 5
    s_mul_i32 s38, s38, 48
    s_lshl_b32 s62, s22, 7
    s_add_u32 s38, s38, s62
    v_add_u32 v28, s38, v28
    v_mul_u32_u24 v28, 0x500, v28
    v_lshl_add_u32 v30, v30, 4, v28
    v_lshl_add_u32 v31, v31, 4, v28
    s_cmp_eq_u32 s41, 7
    s_cselect_b32 s62, -184320, 0
    v_add_u32 v1, 0, v30
    v_add_u32 v2, 9216, v31
    v_add_u32 v3, 18432, v30
    v_add_u32 v4, 30720, v31
    v_add_u32 v5, 39936, v30
    v_add_u32 v5, s62, v5
    v_add_u32 v6, 49152, v31
    v_add_u32 v6, s62, v6
    s_waitcnt lgkmcnt(0)
    s_mov_b32 s28, s4
    s_mov_b32 s29, s5
K1F_loads:
    s_mul_i32 s44, s36, s50
    s_mul_i32 s45, s50, 10
    s_mov_b32 s24, s4
    s_mov_b32 s25, s5
    s_mov_b32 s32, s14
    s_mov_b32 s33, s15
    s_mov_b32 s34, 3456
    s_mov_b32 s35, 0x20000
    s_lshl_b32 s52, s47, 8
    s_lshl_b32 s53, s47, 5
    s_add_u32 s53, s53, 192
    v_lshlrev_b32 v32, 3, v21
    v_add_u32 v32, s37, v32
    buffer_load_dwordx2 v[100:101], v32, s[32:35], s52 offen offset:0
    buffer_load_dwordx2 v[102:103], v32, s[32:35], s52 offen offset:32
    buffer_load_dwordx2 v[104:105], v32, s[32:35], s52 offen offset:64
    buffer_load_dwordx2 v[106:107], v32, s[32:35], s52 offen offset:96
    buffer_load_dwordx2 v[108:109], v32, s[32:35], s52 offen offset:128
    buffer_load_dwordx2 v[110:111], v32, s[32:35], s52 offen offset:160
    buffer_load_dwordx2 v[112:113], v32, s[32:35], s53 offen
    s_mov_b32 m0, s49
    s_nop 0
    buffer_load_dwordx4 v1, s[28:31], s44 offen offset:0 lds
    buffer_load_dwordx4 v2, s[28:31], s44 offen offset:1024 lds
    buffer_load_dwordx4 v3, s[28:31], s44 offen offset:2048 lds
    s_add_u32 m0, m0, 3072
    s_nop 0
    buffer_load_dwordx4 v4, s[28:31], s44 offen offset:0 lds
    buffer_load_dwordx4 v5, s[28:31], s44 offen offset:1024 lds
    buffer_load_dwordx4 v6, s[28:31], s44 offen offset:2048 lds
    s_add_u32 s44, s44, s50
    s_cmp_eq_u32 s44, s45
    s_cselect_b32 s44, 0, s44
    s_add_u32 s49, s49, 49152
    s_cmp_eq_u32 s49, s48
    s_cselect_b32 s49, s39, s49
    s_mov_b32 m0, s49
    v_lshrrev_b32 v28, 5, v9
    v_lshlrev_b32 v28, 4, v28
    v_bfe_u32 v29, v9, 2, 3
    v_add_u32 v28, v28, v29
    v_mul_u32_u24 v28, 480, v28
    v_and_b32 v29, 3, v9
    v_lshl_add_u32 v27, v29, 3, v28
    v_lshrrev_b32 v30, 1, v20
    v_xor_b32 v30, v21, v30
    v_lshlrev_b32 v31, 7, v20
    v_lshl_add_u32 v30, v30, 4, v31
    v_xor_b32 v31, 64, v30
    s_lshl_b32 s63, s20, 12
    s_add_u32 s63, s63, 30720
    v_add_u32 v16, s63, v30
    v_add_u32 v17, s63, v31
    s_mov_b32 s51, 10
    s_mov_b32 s57, 49152
    s_mov_b32 s58, 1
    s_mov_b32 s59, 49152
    v_add_u32 v10, s52, v27
    v_add_u32 v11, s53, v27
    s_lshl_b32 s83, s22, 3
    s_add_u32 s83, s83, s23
    s_sub_u32 s62, s83, 34
    s_mov_b32 s81, 2215936
    s_cmp_lt_u32 s83, 34
    s_cselect_b32 s83, s83, s62
    s_cselect_b32 s74, s8, s16
    s_cselect_b32 s75, s9, s17
    s_cselect_b32 s76, 823296, s81
    s_cselect_b32 s82, 0, 20
    s_cselect_b32 s77, 20, 54
    s_sub_u32 s74, s74, 4096
    s_subb_u32 s75, s75, 0
    s_mul_i32 s83, s83, 6
    v_lshrrev_b32 v158, 3, v9
    s_lshl_b32 s62, s41, 2
    v_add_u32 v158, s62, v158
    v_mul_u32_u24 v158, 0x500, v158
    v_and_b32 v159, 7, v9
    v_lshl_add_u32 v158, v159, 4, v158
    v_mov_b32 v159, 0x7f000000
    v_cmp_gt_u32 vcc, 32, v9
    s_nop 1
    v_cndmask_b32 v158, v159, v158, vcc
    s_add_u32 s62, s83, 0
    s_mul_i32 s63, s62, 0x667
    s_lshr_b32 s63, s63, 14
    s_mul_i32 s72, s63, 10
    s_sub_u32 s72, s62, s72
    s_mul_i32 s63, s63, 40960
    s_lshl_b32 s72, s72, 7
    s_add_u32 s63, s63, s72
    s_add_u32 s63, s63, 4096
    v_add_u32 v114, s63, v158
    s_add_u32 s62, s83, 1
    s_mul_i32 s63, s62, 0x667
    s_lshr_b32 s63, s63, 14
    s_mul_i32 s72, s63, 10
    s_sub_u32 s72, s62, s72
    s_mul_i32 s63, s63, 40960
    s_lshl_b32 s72, s72, 7
    s_add_u32 s63, s63, s72
    s_add_u32 s63, s63, 3072
    v_add_u32 v115, s63, v158
    s_add_u32 s62, s83, 2
    s_mul_i32 s63, s62, 0x667
    s_lshr_b32 s63, s63, 14
    s_mul_i32 s72, s63, 10
    s_sub_u32 s72, s62, s72
    s_mul_i32 s63, s63, 40960
    s_lshl_b32 s72, s72, 7
    s_add_u32 s63, s63, s72
    s_add_u32 s63, s63, 2048
    v_add_u32 v116, s63, v158
    s_add_u32 s62, s83, 3
    s_mul_i32 s63, s62, 0x667
    s_lshr_b32 s63, s63, 14
    s_mul_i32 s72, s63, 10
    s_sub_u32 s72, s62, s72
    s_mul_i32 s63, s63, 40960
    s_lshl_b32 s72, s72, 7
    s_add_u32 s63, s63, s72
    s_add_u32 s63, s63, 4096
    v_add_u32 v117, s63, v158
    s_add_u32 s62, s83, 4
    s_mul_i32 s63, s62, 0x667
    s_lshr_b32 s63, s63, 14
    s_mul_i32 s72, s63, 10
    s_sub_u32 s72, s62, s72
    s_mul_i32 s63, s63, 40960
    s_lshl_b32 s72, s72, 7
    s_add_u32 s63, s63, s72
    s_add_u32 s63, s63, 3072
    v_add_u32 v118, s63, v158
    s_add_u32 s62, s83, 5
    s_mul_i32 s63, s62, 0x667
    s_lshr_b32 s63, s63, 14
    s_mul_i32 s72, s63, 10
    s_sub_u32 s72, s62, s72
    s_mul_i32 s63, s63, 40960
    s_lshl_b32 s72, s72, 7
    s_add_u32 s63, s63, s72
    s_add_u32 s63, s63, 2048
    v_add_u32 v119, s63, v158
    s_nop 0
    buffer_load_dwordx4 v1, s[28:31], s44 offen offset:0 lds
    buffer_load_dwordx4 v2, s[28:31], s44 offen offset:1024 lds
    buffer_load_dwordx4 v3, s[28:31], s44 offen offset:2048 lds
    s_add_u32 m0, m0, 3072
    s_nop 0
    buffer_load_dwordx4 v4, s[28:31], s44 offen offset:0 lds
    buffer_load_dwordx4 v5, s[28:31], s44 offen offset:1024 lds
    buffer_load_dwordx4 v6, s[28:31], s44 offen offset:2048 lds
    s_add_u32 s44, s44, s50
    s_cmp_eq_u32 s44, s45
    s_cselect_b32 s44, 0, s44
    s_add_u32 s49, s49, 49152
    s_cmp_eq_u32 s49, s48
    s_cselect_b32 s49, s39, s49
    s_mov_b32 m0, s49
    s_waitcnt vmcnt(12)
    v_lshlrev_b32 v32, 16, v100
    v_and_b32 v33, 0xffff0000, v100
    v_lshlrev_b32 v34, 16, v101
    v_and_b32 v35, 0xffff0000, v101
    v_lshlrev_b32 v60, 16, v100
    v_and_b32 v61, 0xffff0000, v100
    v_lshlrev_b32 v62, 16, v101
    v_and_b32 v63, 0xffff0000, v101
    v_lshlrev_b32 v36, 16, v102
    v_and_b32 v37, 0xffff0000, v102
    v_lshlrev_b32 v38, 16, v103
    v_and_b32 v39, 0xffff0000, v103
    v_lshlrev_b32 v64, 16, v102
    v_and_b32 v65, 0xffff0000, v102
    v_lshlrev_b32 v66, 16, v103
    v_and_b32 v67, 0xffff0000, v103
    v_lshlrev_b32 v40, 16, v104
    v_and_b32 v41, 0xffff0000, v104
    v_lshlrev_b32 v42, 16, v105
    v_and_b32 v43, 0xffff0000, v105
    v_lshlrev_b32 v68, 16, v104
    v_and_b32 v69, 0xffff0000, v104
    v_lshlrev_b32 v70, 16, v105
    v_and_b32 v71, 0xffff0000, v105
    v_lshlrev_b32 v44, 16, v106
    v_and_b32 v45, 0xffff0000, v106
    v_lshlrev_b32 v46, 16, v107
    v_and_b32 v47, 0xffff0000, v107
    v_lshlrev_b32 v72, 16, v106
    v_and_b32 v73, 0xffff0000, v106
    v_lshlrev_b32 v74, 16, v107
    v_and_b32 v75, 0xffff0000, v107
    v_lshlrev_b32 v48, 16, v108
    v_and_b32 v49, 0xffff0000, v108
    v_lshlrev_b32 v50, 16, v109
    v_and_b32 v51, 0xffff0000, v109
    v_lshlrev_b32 v76, 16, v108
    v_and_b32 v77, 0xffff0000, v108
    v_lshlrev_b32 v78, 16, v109
    v_and_b32 v79, 0xffff0000, v109
    v_lshlrev_b32 v52, 16, v110
    v_and_b32 v53, 0xffff0000, v110
    v_lshlrev_b32 v54, 16, v111
    v_and_b32 v55, 0xffff0000, v111
    v_lshlrev_b32 v80, 16, v110
    v_and_b32 v81, 0xffff0000, v110
    v_lshlrev_b32 v82, 16, v111
    v_and_b32 v83, 0xffff0000, v111
    v_lshlrev_b32 v56, 16, v112
    v_and_b32 v57, 0xffff0000, v112
    v_lshlrev_b32 v58, 16, v113
    v_and_b32 v59, 0xffff0000, v113
    v_lshlrev_b32 v84, 16, v112
    v_and_b32 v85, 0xffff0000, v112
    v_lshlrev_b32 v86, 16, v113
    v_and_b32 v87, 0xffff0000, v113
    s_waitcnt vmcnt(6)
    s_barrier
    ds_read_b128 a[64:67], v16 offset:0
    ds_read_b128 a[68:71], v16 offset:2048
    ds_read_b64_tr_b16 a[0:1], v10 offset:0
    ds_read_b64_tr_b16 a[2:3], v10 offset:3840
    ds_read_b64_tr_b16 a[4:5], v10 offset:32
    ds_read_b64_tr_b16 a[6:7], v10 offset:3872
    ds_read_b64_tr_b16 a[8:9], v10 offset:64
    ds_read_b64_tr_b16 a[10:11], v10 offset:3904
    ds_read_b64_tr_b16 a[12:13], v10 offset:96
    ds_read_b64_tr_b16 a[14:15], v10 offset:3936
    ds_read_b64_tr_b16 a[16:17], v10 offset:128
    ds_read_b64_tr_b16 a[18:19], v10 offset:3968
    ds_read_b64_tr_b16 a[20:21], v10 offset:160
    ds_read_b64_tr_b16 a[22:23], v10 offset:4000
    ds_read_b64_tr_b16 a[24:25], v11 offset:0
    ds_read_b64_tr_b16 a[26:27], v11 offset:3840
    buffer_load_dwordx4 v1, s[28:31], s44 offen offset:0 lds
    buffer_load_dwordx4 v2, s[28:31], s44 offen offset:1024 lds
    buffer_load_dwordx4 v3, s[28:31], s44 offen offset:2048 lds
    s_add_u32 m0, m0, 3072
K1F_loop:
    s_waitcnt lgkmcnt(10)
    v_mfma_f32_16x16x32_bf16 v[32:35], a[0:3], a[64:67], v[32:35]
    ds_read_b128 a[76:79], v17 offset:0
    ds_read_b128 a[80:83], v17 offset:2048
    v_mfma_f32_16x16x32_bf16 v[60:63], a[0:3], a[68:71], v[60:63]
    ds_read_b64_tr_b16 a[32:33], v10 offset:15360
    v_mfma_f32_16x16x32_bf16 v[36:39], a[4:7], a[64:67], v[36:39]
    ds_read_b64_tr_b16 a[34:35], v10 offset:19200
    buffer_load_dwordx4 v4, s[28:31], s44 offen offset:0 lds
    v_mfma_f32_16x16x32_bf16 v[64:67], a[4:7], a[68:71], v[64:67]
    ds_read_b64_tr_b16 a[36:37], v10 offset:15392
    s_waitcnt lgkmcnt(11)
    v_mfma_f32_16x16x32_bf16 v[40:43], a[8:11], a[64:67], v[40:43]
    ds_read_b64_tr_b16 a[38:39], v10 offset:19232
    v_mfma_f32_16x16x32_bf16 v[68:71], a[8:11], a[68:71], v[68:71]
    ds_read_b64_tr_b16 a[40:41], v10 offset:15424
    v_mfma_f32_16x16x32_bf16 v[44:47], a[12:15], a[64:67], v[44:47]
    ds_read_b64_tr_b16 a[42:43], v10 offset:19264
    buffer_load_dwordx4 v5, s[28:31], s44 offen offset:1024 lds
    v_mfma_f32_16x16x32_bf16 v[72:75], a[12:15], a[68:71], v[72:75]
    ds_read_b64_tr_b16 a[44:45], v10 offset:15456
    ds_read_b64_tr_b16 a[46:47], v10 offset:19296
    s_waitcnt lgkmcnt(12)
    v_mfma_f32_16x16x32_bf16 v[48:51], a[16:19], a[64:67], v[48:51]
    ds_read_b64_tr_b16 a[48:49], v10 offset:15488
    v_mfma_f32_16x16x32_bf16 v[76:79], a[16:19], a[68:71], v[76:79]
    ds_read_b64_tr_b16 a[50:51], v10 offset:19328
    v_mfma_f32_16x16x32_bf16 v[52:55], a[20:23], a[64:67], v[52:55]
    ds_read_b64_tr_b16 a[52:53], v10 offset:15520
    buffer_load_dwordx4 v6, s[28:31], s44 offen offset:2048 lds
    v_mfma_f32_16x16x32_bf16 v[80:83], a[20:23], a[68:71], v[80:83]
    ds_read_b64_tr_b16 a[54:55], v10 offset:19360
    s_waitcnt lgkmcnt(12)
    v_mfma_f32_16x16x32_bf16 v[56:59], a[24:27], a[64:67], v[56:59]
    ds_read_b64_tr_b16 a[56:57], v11 offset:15360
    v_mfma_f32_16x16x32_bf16 v[84:87], a[24:27], a[68:71], v[84:87]
    ds_read_b64_tr_b16 a[58:59], v11 offset:19200
    s_waitcnt lgkmcnt(10)
    v_mfma_f32_16x16x32_bf16 v[32:35], a[32:35], a[76:79], v[32:35]
    s_add_u32 s44, s44, s50
    s_cmp_eq_u32 s44, s45
    s_cselect_b32 s44, 0, s44
    s_add_u32 s49, s49, 49152
    s_cmp_eq_u32 s49, s48
    s_cselect_b32 s49, s39, s49
    v_mfma_f32_16x16x32_bf16 v[60:63], a[32:35], a[80:83], v[60:63]
    s_cmp_eq_u32 s49, s46
    s_cselect_b32 s57, -98304, s59
    s_mov_b32 m0, s49
    s_cmp_le_u32 s51, 3
    s_cbranch_scc1 K1F_tail
K1F_tailed:
    v_mfma_f32_16x16x32_bf16 v[36:39], a[36:39], a[76:79], v[36:39]
    v_add_u32 v10, s57, v10
    v_add_u32 v11, s57, v11
    v_mfma_f32_16x16x32_bf16 v[64:67], a[36:39], a[80:83], v[64:67]
    v_add_u32 v16, s57, v16
    v_add_u32 v17, s57, v17
K1F_mid:
    s_waitcnt vmcnt(6) lgkmcnt(0)
    s_cmp_eq_u32 s51, 1
    s_barrier
    s_cbranch_scc1 K1F_last
    v_mfma_f32_16x16x32_bf16 v[40:43], a[40:43], a[76:79], v[40:43]
    ds_read_b128 a[64:67], v16 offset:0
    ds_read_b128 a[68:71], v16 offset:2048
    v_mfma_f32_16x16x32_bf16 v[68:71], a[40:43], a[80:83], v[68:71]
    ds_read_b64_tr_b16 a[0:1], v10 offset:0
    ds_read_b64_tr_b16 a[2:3], v10 offset:3840
    buffer_load_dwordx4 v1, s[28:31], s44 offen offset:0 lds
    v_mfma_f32_16x16x32_bf16 v[44:47], a[44:47], a[76:79], v[44:47]
    ds_read_b64_tr_b16 a[4:5], v10 offset:32
    v_mfma_f32_16x16x32_bf16 v[72:75], a[44:47], a[80:83], v[72:75]
    ds_read_b64_tr_b16 a[6:7], v10 offset:3872
    ds_read_b64_tr_b16 a[8:9], v10 offset:64
    v_mfma_f32_16x16x32_bf16 v[48:51], a[48:51], a[76:79], v[48:51]
    ds_read_b64_tr_b16 a[10:11], v10 offset:3904
    buffer_load_dwordx4 v2, s[28:31], s44 offen offset:1024 lds
    v_mfma_f32_16x16x32_bf16 v[76:79], a[48:51], a[80:83], v[76:79]
    ds_read_b64_tr_b16 a[12:13], v10 offset:96
    ds_read_b64_tr_b16 a[14:15], v10 offset:3936
    v_mfma_f32_16x16x32_bf16 v[52:55], a[52:55], a[76:79], v[52:55]
    ds_read_b64_tr_b16 a[16:17], v10 offset:128
    ds_read_b64_tr_b16 a[18:19], v10 offset:3968
    v_mfma_f32_16x16x32_bf16 v[80:83], a[52:55], a[80:83], v[80:83]
    ds_read_b64_tr_b16 a[20:21], v10 offset:160
    buffer_load_dwordx4 v3, s[28:31], s44 offen offset:2048 lds
    s_add_u32 m0, m0, 3072
    v_mfma_f32_16x16x32_bf16 v[56:59], a[56:59], a[76:79], v[56:59]
    ds_read_b64_tr_b16 a[22:23], v10 offset:4000
    ds_read_b64_tr_b16 a[24:25], v11 offset:0
    v_mfma_f32_16x16x32_bf16 v[84:87], a[56:59], a[80:83], v[84:87]
    ds_read_b64_tr_b16 a[26:27], v11 offset:3840
    s_sub_u32 s51, s51, 1
    s_branch K1F_loop
K1F_last:
    v_mfma_f32_16x16x32_bf16 v[40:43], a[40:43], a[76:79], v[40:43]
    v_mul_u32_u24 v158, 6144, v21
    v_bfe_u32 v159, v9, 2, 2
    v_lshl_add_u32 v158, v159, 7, v158
    v_and_b32 v159, 3, v9
    v_mfma_f32_16x16x32_bf16 v[68:71], a[40:43], a[80:83], v[68:71]
    v_lshl_add_u32 v158, v159, 3, v158
    s_lshl_b32 s62, s20, 5
    s_mul_i32 s63, s47, 3072
    s_add_u32 s62, s62, s63
    v_mfma_f32_16x16x32_bf16 v[44:47], a[44:47], a[76:79], v[44:47]
    s_add_u32 s62, s62, 49152
    v_add_u32 v158, s62, v158
    s_add_u32 s68, s10, 10485760
    s_addc_u32 s69, s11, 0
    v_mfma_f32_16x16x32_bf16 v[72:75], a[44:47], a[80:83], v[72:75]
    s_mov_b32 s70, 3031040
    s_mov_b32 s71, 0x20000
    v_lshlrev_b32 v159, 4, v9
    ds_read_b64_tr_b16 v[140:141], v158 offset:0
    v_mfma_f32_16x16x32_bf16 v[48:51], a[48:51], a[76:79], v[48:51]
    ds_read_b64_tr_b16 v[142:143], v158 offset:24576
    ds_read_b64_tr_b16 v[144:145], v158 offset:1024
    ds_read_b64_tr_b16 v[146:147], v158 offset:25600
    ds_read_b64_tr_b16 v[148:149], v158 offset:2048
    v_mfma_f32_16x16x32_bf16 v[76:79], a[48:51], a[80:83], v[76:79]
    ds_read_b64_tr_b16 v[150:151], v158 offset:26624
    s_mul_i32 s74, s47, 3
    s_add_u32 s74, s74, s83
    s_add_u32 s62, s74, 0
    v_mfma_f32_16x16x32_bf16 v[52:55], a[52:55], a[76:79], v[52:55]
    s_mul_i32 s75, s62, 0x667
    s_lshr_b32 s75, s75, 14
    s_mul_i32 s72, s75, 10
    s_sub_u32 s72, s62, s72
    v_mfma_f32_16x16x32_bf16 v[80:83], a[52:55], a[80:83], v[80:83]
    s_lshl_b32 s72, s72, 2
    s_add_u32 s72, s72, s20
    s_mul_i32 s62, s72, 52
    s_lshr_b32 s62, s62, 8
    v_mfma_f32_16x16x32_bf16 v[56:59], a[56:59], a[76:79], v[56:59]
    s_mul_i32 s63, s62, 5
    s_sub_u32 s63, s72, s63
    s_mul_i32 s62, s62, 74
    s_add_u32 s62, s62, s75
    v_mfma_f32_16x16x32_bf16 v[84:87], a[56:59], a[80:83], v[84:87]
    s_add_u32 s62, s62, s82
    s_mul_i32 s62, s62, 5
    s_add_u32 s62, s62, s63
    s_lshl_b32 s62, s62, 10
    s_nop 7
    s_cmp_ge_u32 s75, s77
    s_cselect_b32 s62, 0x7f000000, s62
    s_waitcnt lgkmcnt(4)
    buffer_store_dwordx4 v[140:143], v159, s[68:71], s62 offen sc1
    s_add_u32 s62, s74, 1
    s_mul_i32 s75, s62, 0x667
    s_lshr_b32 s75, s75, 14
    s_mul_i32 s72, s75, 10
    s_sub_u32 s72, s62, s72
    s_lshl_b32 s72, s72, 2
    s_add_u32 s72, s72, s20
    s_mul_i32 s62, s72, 52
    s_lshr_b32 s62, s62, 8
    s_mul_i32 s63, s62, 5
    s_sub_u32 s63, s72, s63
    s_mul_i32 s62, s62, 74
    s_add_u32 s62, s62, s75
    s_add_u32 s62, s62, s82
    s_mul_i32 s62, s62, 5
    s_add_u32 s62, s62, s63
    s_lshl_b32 s62, s62, 10
    s_cmp_ge_u32 s75, s77
    s_cselect_b32 s62, 0x7f000000, s62
    s_waitcnt lgkmcnt(2)
    buffer_store_dwordx4 v[144:147], v159, s[68:71], s62 offen sc1
    s_add_u32 s62, s74, 2
    s_mul_i32 s75, s62, 0x667
    s_lshr_b32 s75, s75, 14
    s_mul_i32 s72, s75, 10
    s_sub_u32 s72, s62, s72
    s_lshl_b32 s72, s72, 2
    s_add_u32 s72, s72, s20
    s_mul_i32 s62, s72, 52
    s_lshr_b32 s62, s62, 8
    s_mul_i32 s63, s62, 5
    s_sub_u32 s63, s72, s63
    s_mul_i32 s62, s62, 74
    s_add_u32 s62, s62, s75
    s_add_u32 s62, s62, s82
    s_mul_i32 s62, s62, 5
    s_add_u32 s62, s62, s63
    s_lshl_b32 s62, s62, 10
    s_cmp_ge_u32 s75, s77
    s_cselect_b32 s62, 0x7f000000, s62
    s_waitcnt lgkmcnt(0)
    buffer_store_dwordx4 v[148:151], v159, s[68:71], s62 offen sc1
    s_nop 1
    s_add_u32 s32, s10, 0
    s_addc_u32 s33, s11, 0
    s_mov_b32 s34, 9699328
    s_mov_b32 s35, 0x20000
    s_lshl_b32 s60, s22, 3
    s_lshl_b32 s61, s20, 1
    s_add_u32 s60, s60, s61
    s_lshr_b32 s61, s60, 2
    s_mul_i32 s61, s61, 296
    s_and_b32 s60, s60, 3
    s_add_u32 s60, s60, s61
    s_lshl_b32 s60, s60, 10
    s_cmp_eq_u32 s47, 0
    s_cbranch_scc0 K1F_mish
    s_lshl_b32 s62, s22, 7
    s_lshl_b32 s63, s23, 4
    s_add_u32 s62, s62, s63
    s_lshl_b32 s63, s20, 2
    s_add_u32 s62, s62, s63
    v_add_u32 v156, s62, v21
    v_mul_u32_u24 v157, 80, v20
    v_mul_u32_u24 v158, 0x500, v156
    v_add_u32 v158, v158, v157
    s_mov_b32 s84, s18
    s_mov_b32 s85, s19
    s_mov_b32 s86, 1280
    s_mov_b32 s87, 0x20000
    buffer_load_dwordx4 v[112:115], v158, s[24:27], 0 offen offset:0
    buffer_load_dwordx4 v[132:135], v157, s[84:87], 0 offen offset:0
    buffer_load_dwordx4 v[116:119], v158, s[24:27], 0 offen offset:16
    buffer_load_dwordx4 v[136:139], v157, s[84:87], 0 offen offset:16
    buffer_load_dwordx4 v[120:123], v158, s[24:27], 0 offen offset:32
    buffer_load_dwordx4 v[140:143], v157, s[84:87], 0 offen offset:32
    buffer_load_dwordx4 v[124:127], v158, s[24:27], 0 offen offset:48
    buffer_load_dwordx4 v[144:147], v157, s[84:87], 0 offen offset:48
    buffer_load_dwordx4 v[128:131], v158, s[24:27], 0 offen offset:64
    buffer_load_dwordx4 v[148:151], v157, s[84:87], 0 offen offset:64
K1F_mish:
    s_add_u32 s62, s42, 20
    s_lshl_b32 s62, s62, 12
    s_add_u32 s62, s62, s60
    s_lshl_b32 s63, s47, 3
    s_add_u32 s63, s63, s62
    s_add_u32 s63, s63, 12288
    s_lshl_b32 s66, s47, 14
    s_add_u32 s62, s62, s66
    v_lshlrev_b32 v159, 4, v9
    s_mov_b32 s88, 0x3fb8aa3b
    s_mov_b32 s89, 0x3fb8aa3b
    v_mov_b32 v104, 1.0
    v_mov_b32 v105, 1.0
    v_mov_b32 v106, 0xc1700000
    v_mov_b32 v107, 0xc1700000
    s_mov_b32 s78, 0x47000000
    s_mov_b32 s79, 0x47000000
    v_pk_fma_f32 v[88:89], v[32:33], s[88:89], v[106:107]
    v_pk_fma_f32 v[90:91], v[34:35], s[88:89], v[106:107]
    v_pk_fma_f32 v[92:93], v[36:37], s[88:89], v[106:107]
    v_pk_fma_f32 v[94:95], v[38:39], s[88:89], v[106:107]
    v_exp_f32_e64 v88, v88 clamp
    v_exp_f32_e64 v89, v89 clamp
    v_exp_f32_e64 v90, v90 clamp
    v_exp_f32_e64 v91, v91 clamp
    v_exp_f32_e64 v92, v92 clamp
    v_exp_f32_e64 v93, v93 clamp
    v_exp_f32_e64 v94, v94 clamp
    v_exp_f32_e64 v95, v95 clamp
    v_pk_fma_f32 v[88:89], v[88:89], s[78:79], v[104:105]
    v_pk_fma_f32 v[90:91], v[90:91], s[78:79], v[104:105]
    v_pk_fma_f32 v[92:93], v[92:93], s[78:79], v[104:105]
    v_pk_fma_f32 v[94:95], v[94:95], s[78:79], v[104:105]
    v_pk_fma_f32 v[88:89], v[88:89], v[88:89], v[104:105]
    v_pk_fma_f32 v[90:91], v[90:91], v[90:91], v[104:105]
    v_pk_fma_f32 v[92:93], v[92:93], v[92:93], v[104:105]
    v_pk_fma_f32 v[94:95], v[94:95], v[94:95], v[104:105]
    v_pk_mul_f32 v[108:109], v[88:89], v[90:91]
    v_pk_mul_f32 v[152:153], v[92:93], v[94:95]
    v_mul_f32 v110, v108, v109
    v_mul_f32 v154, v152, v153
    v_rcp_f32 v110, v110
    v_rcp_f32 v154, v154
    s_nop 0
    v_mul_f32 v110, -2.0, v110
    v_mul_f32 v154, -2.0, v154
    v_pk_mul_f32 v[108:109], v[110:111], v[108:109] op_sel:[0,1] op_sel_hi:[0,0]
    v_pk_mul_f32 v[152:153], v[154:155], v[152:153] op_sel:[0,1] op_sel_hi:[0,0]
    v_pk_fma_f32 v[110:111], v[108:109], v[90:91], v[104:105]
    v_pk_fma_f32 v[90:91], v[108:109], v[88:89], v[104:105]
    v_pk_mul_f32 v[88:89], v[110:111], v[32:33]
    v_pk_mul_f32 v[90:91], v[90:91], v[34:35]
    v_pk_fma_f32 v[154:155], v[152:153], v[94:95], v[104:105]
    v_pk_fma_f32 v[94:95], v[152:153], v[92:93], v[104:105]
    v_pk_mul_f32 v[92:93], v[154:155], v[36:37]
    v_pk_mul_f32 v[94:95], v[94:95], v[38:39]
    v_cvt_pk_bf16_f32 v32, v88, v89
    v_cvt_pk_bf16_f32 v33, v90, v91
    v_cvt_pk_bf16_f32 v34, v92, v93
    v_cvt_pk_bf16_f32 v35, v94, v95
    buffer_store_dwordx4 v[32:35], v159, s[32:35], s62 offen offset:0 sc1
    v_pk_fma_f32 v[96:97], v[60:61], s[88:89], v[106:107]
    v_pk_fma_f32 v[98:99], v[62:63], s[88:89], v[106:107]
    v_pk_fma_f32 v[100:101], v[64:65], s[88:89], v[106:107]
    v_pk_fma_f32 v[102:103], v[66:67], s[88:89], v[106:107]
    v_exp_f32_e64 v96, v96 clamp
    v_exp_f32_e64 v97, v97 clamp
    v_exp_f32_e64 v98, v98 clamp
    v_exp_f32_e64 v99, v99 clamp
    v_exp_f32_e64 v100, v100 clamp
    v_exp_f32_e64 v101, v101 clamp
    v_exp_f32_e64 v102, v102 clamp
    v_exp_f32_e64 v103, v103 clamp
    v_pk_fma_f32 v[96:97], v[96:97], s[78:79], v[104:105]
    v_pk_fma_f32 v[98:99], v[98:99], s[78:79], v[104:105]
    v_pk_fma_f32 v[100:101], v[100:101], s[78:79], v[104:105]
    v_pk_fma_f32 v[102:103], v[102:103], s[78:79], v[104:105]
    v_pk_fma_f32 v[96:97], v[96:97], v[96:97], v[104:105]
    v_pk_fma_f32 v[98:99], v[98:99], v[98:99], v[104:105]
    v_pk_fma_f32 v[100:101], v[100:101], v[100:101], v[104:105]
    v_pk_fma_f32 v[102:103], v[102:103], v[102:103], v[104:105]
    v_pk_mul_f32 v[108:109], v[96:97], v[98:99]
    v_pk_mul_f32 v[152:153], v[100:101], v[102:103]
    v_mul_f32 v110, v108, v109
    v_mul_f32 v154, v152, v153
    v_rcp_f32 v110, v110
    v_rcp_f32 v154, v154
    s_nop 0
    v_mul_f32 v110, -2.0, v110
    v_mul_f32 v154, -2.0, v154
    v_pk_mul_f32 v[108:109], v[110:111], v[108:109] op_sel:[0,1] op_sel_hi:[0,0]
    v_pk_mul_f32 v[152:153], v[154:155], v[152:153] op_sel:[0,1] op_sel_hi:[0,0]
    v_pk_fma_f32 v[110:111], v[108:109], v[98:99], v[104:105]
    v_pk_fma_f32 v[98:99], v[108:109], v[96:97], v[104:105]
    v_pk_mul_f32 v[96:97], v[110:111], v[60:61]
    v_pk_mul_f32 v[98:99], v[98:99], v[62:63]
    v_pk_fma_f32 v[154:155], v[152:153], v[102:103], v[104:105]
    v_pk_fma_f32 v[102:103], v[152:153], v[100:101], v[104:105]
    v_pk_mul_f32 v[100:101], v[154:155], v[64:65]
    v_pk_mul_f32 v[102:103], v[102:103], v[66:67]
    v_cvt_pk_bf16_f32 v60, v96, v97
    v_cvt_pk_bf16_f32 v61, v98, v99
    v_cvt_pk_bf16_f32 v62, v100, v101
    v_cvt_pk_bf16_f32 v63, v102, v103
    buffer_store_dwordx4 v[60:63], v159, s[32:35], s62 offen offset:1024 sc1
    s_add_u32 s62, s62, 4096
    v_pk_fma_f32 v[88:89], v[40:41], s[88:89], v[106:107]
    v_pk_fma_f32 v[90:91], v[42:43], s[88:89], v[106:107]
    v_pk_fma_f32 v[92:93], v[44:45], s[88:89], v[106:107]
    v_pk_fma_f32 v[94:95], v[46:47], s[88:89], v[106:107]
    v_exp_f32_e64 v88, v88 clamp
    v_exp_f32_e64 v89, v89 clamp
    v_exp_f32_e64 v90, v90 clamp
    v_exp_f32_e64 v91, v91 clamp
    v_exp_f32_e64 v92, v92 clamp
    v_exp_f32_e64 v93, v93 clamp
    v_exp_f32_e64 v94, v94 clamp
    v_exp_f32_e64 v95, v95 clamp
    v_pk_fma_f32 v[88:89], v[88:89], s[78:79], v[104:105]
    v_pk_fma_f32 v[90:91], v[90:91], s[78:79], v[104:105]
    v_pk_fma_f32 v[92:93], v[92:93], s[78:79], v[104:105]
    v_pk_fma_f32 v[94:95], v[94:95], s[78:79], v[104:105]
    v_pk_fma_f32 v[88:89], v[88:89], v[88:89], v[104:105]
    v_pk_fma_f32 v[90:91], v[90:91], v[90:91], v[104:105]
    v_pk_fma_f32 v[92:93], v[92:93], v[92:93], v[104:105]
    v_pk_fma_f32 v[94:95], v[94:95], v[94:95], v[104:105]
    v_pk_mul_f32 v[108:109], v[88:89], v[90:91]
    v_pk_mul_f32 v[152:153], v[92:93], v[94:95]
    v_mul_f32 v110, v108, v109
    v_mul_f32 v154, v152, v153
    v_rcp_f32 v110, v110
    v_rcp_f32 v154, v154
    s_nop 0
    v_mul_f32 v110, -2.0, v110
    v_mul_f32 v154, -2.0, v154
    v_pk_mul_f32 v[108:109], v[110:111], v[108:109] op_sel:[0,1] op_sel_hi:[0,0]
    v_pk_mul_f32 v[152:153], v[154:155], v[152:153] op_sel:[0,1] op_sel_hi:[0,0]
    v_pk_fma_f32 v[110:111], v[108:109], v[90:91], v[104:105]
    v_pk_fma_f32 v[90:91], v[108:109], v[88:89], v[104:105]
    v_pk_mul_f32 v[88:89], v[110:111], v[40:41]
    v_pk_mul_f32 v[90:91], v[90:91], v[42:43]
    v_pk_fma_f32 v[154:155], v[152:153], v[94:95], v[104:105]
    v_pk_fma_f32 v[94:95], v[152:153], v[92:93], v[104:105]
    v_pk_mul_f32 v[92:93], v[154:155], v[44:45]
    v_pk_mul_f32 v[94:95], v[94:95], v[46:47]
    v_cvt_pk_bf16_f32 v40, v88, v89
    v_cvt_pk_bf16_f32 v41, v90, v91
    v_cvt_pk_bf16_f32 v42, v92, v93
    v_cvt_pk_bf16_f32 v43, v94, v95
    buffer_store_dwordx4 v[40:43], v159, s[32:35], s62 offen offset:0 sc1
    v_pk_fma_f32 v[96:97], v[68:69], s[88:89], v[106:107]
    v_pk_fma_f32 v[98:99], v[70:71], s[88:89], v[106:107]
    v_pk_fma_f32 v[100:101], v[72:73], s[88:89], v[106:107]
    v_pk_fma_f32 v[102:103], v[74:75], s[88:89], v[106:107]
    v_exp_f32_e64 v96, v96 clamp
    v_exp_f32_e64 v97, v97 clamp
    v_exp_f32_e64 v98, v98 clamp
    v_exp_f32_e64 v99, v99 clamp
    v_exp_f32_e64 v100, v100 clamp
    v_exp_f32_e64 v101, v101 clamp
    v_exp_f32_e64 v102, v102 clamp
    v_exp_f32_e64 v103, v103 clamp
    v_pk_fma_f32 v[96:97], v[96:97], s[78:79], v[104:105]
    v_pk_fma_f32 v[98:99], v[98:99], s[78:79], v[104:105]
    v_pk_fma_f32 v[100:101], v[100:101], s[78:79], v[104:105]
    v_pk_fma_f32 v[102:103], v[102:103], s[78:79], v[104:105]
    v_pk_fma_f32 v[96:97], v[96:97], v[96:97], v[104:105]
    v_pk_fma_f32 v[98:99], v[98:99], v[98:99], v[104:105]
    v_pk_fma_f32 v[100:101], v[100:101], v[100:101], v[104:105]
    v_pk_fma_f32 v[102:103], v[102:103], v[102:103], v[104:105]
    v_pk_mul_f32 v[108:109], v[96:97], v[98:99]
    v_pk_mul_f32 v[152:153], v[100:101], v[102:103]
    v_mul_f32 v110, v108, v109
    v_mul_f32 v154, v152, v153
    v_rcp_f32 v110, v110
    v_rcp_f32 v154, v154
    s_nop 0
    v_mul_f32 v110, -2.0, v110
    v_mul_f32 v154, -2.0, v154
    v_pk_mul_f32 v[108:109], v[110:111], v[108:109] op_sel:[0,1] op_sel_hi:[0,0]
    v_pk_mul_f32 v[152:153], v[154:155], v[152:153] op_sel:[0,1] op_sel_hi:[0,0]
    v_pk_fma_f32 v[110:111], v[108:109], v[98:99], v[104:105]
    v_pk_fma_f32 v[98:99], v[108:109], v[96:97], v[104:105]
    v_pk_mul_f32 v[96:97], v[110:111], v[68:69]
    v_pk_mul_f32 v[98:99], v[98:99], v[70:71]
    v_pk_fma_f32 v[154:155], v[152:153], v[102:103], v[104:105]
    v_pk_fma_f32 v[102:103], v[152:153], v[100:101], v[104:105]
    v_pk_mul_f32 v[100:101], v[154:155], v[72:73]
    v_pk_mul_f32 v[102:103], v[102:103], v[74:75]
    v_cvt_pk_bf16_f32 v68, v96, v97
    v_cvt_pk_bf16_f32 v69, v98, v99
    v_cvt_pk_bf16_f32 v70, v100, v101
    v_cvt_pk_bf16_f32 v71, v102, v103
    buffer_store_dwordx4 v[68:71], v159, s[32:35], s62 offen offset:1024 sc1
    s_add_u32 s62, s62, 4096
    s_lshl_b32 s66, s47, 3
    s_add_u32 s66, s66, s23
    s_cmp_lt_u32 s66, 14
    s_cselect_b32 s62, s62, 0x7f000000
    v_pk_fma_f32 v[88:89], v[48:49], s[88:89], v[106:107]
    v_pk_fma_f32 v[90:91], v[50:51], s[88:89], v[106:107]
    v_pk_fma_f32 v[92:93], v[52:53], s[88:89], v[106:107]
    v_pk_fma_f32 v[94:95], v[54:55], s[88:89], v[106:107]
    v_exp_f32_e64 v88, v88 clamp
    v_exp_f32_e64 v89, v89 clamp
    v_exp_f32_e64 v90, v90 clamp
    v_exp_f32_e64 v91, v91 clamp
    v_exp_f32_e64 v92, v92 clamp
    v_exp_f32_e64 v93, v93 clamp
    v_exp_f32_e64 v94, v94 clamp
    v_exp_f32_e64 v95, v95 clamp
    v_pk_fma_f32 v[88:89], v[88:89], s[78:79], v[104:105]
    v_pk_fma_f32 v[90:91], v[90:91], s[78:79], v[104:105]
    v_pk_fma_f32 v[92:93], v[92:93], s[78:79], v[104:105]
    v_pk_fma_f32 v[94:95], v[94:95], s[78:79], v[104:105]
    v_pk_fma_f32 v[88:89], v[88:89], v[88:89], v[104:105]
    v_pk_fma_f32 v[90:91], v[90:91], v[90:91], v[104:105]
    v_pk_fma_f32 v[92:93], v[92:93], v[92:93], v[104:105]
    v_pk_fma_f32 v[94:95], v[94:95], v[94:95], v[104:105]
    v_pk_mul_f32 v[108:109], v[88:89], v[90:91]
    v_pk_mul_f32 v[152:153], v[92:93], v[94:95]
    v_mul_f32 v110, v108, v109
    v_mul_f32 v154, v152, v153
    v_rcp_f32 v110, v110
    v_rcp_f32 v154, v154
    s_nop 0
    v_mul_f32 v110, -2.0, v110
    v_mul_f32 v154, -2.0, v154
    v_pk_mul_f32 v[108:109], v[110:111], v[108:109] op_sel:[0,1] op_sel_hi:[0,0]
    v_pk_mul_f32 v[152:153], v[154:155], v[152:153] op_sel:[0,1] op_sel_hi:[0,0]
    v_pk_fma_f32 v[110:111], v[108:109], v[90:91], v[104:105]
    v_pk_fma_f32 v[90:91], v[108:109], v[88:89], v[104:105]
    v_pk_mul_f32 v[88:89], v[110:111], v[48:49]
    v_pk_mul_f32 v[90:91], v[90:91], v[50:51]
    v_pk_fma_f32 v[154:155], v[152:153], v[94:95], v[104:105]
    v_pk_fma_f32 v[94:95], v[152:153], v[92:93], v[104:105]
    v_pk_mul_f32 v[92:93], v[154:155], v[52:53]
    v_pk_mul_f32 v[94:95], v[94:95], v[54:55]
    v_cvt_pk_bf16_f32 v48, v88, v89
    v_cvt_pk_bf16_f32 v49, v90, v91
    v_cvt_pk_bf16_f32 v50, v92, v93
    v_cvt_pk_bf16_f32 v51, v94, v95
    buffer_store_dwordx4 v[48:51], v159, s[32:35], s62 offen offset:0 sc1
    v_pk_fma_f32 v[96:97], v[76:77], s[88:89], v[106:107]
    v_pk_fma_f32 v[98:99], v[78:79], s[88:89], v[106:107]
    v_pk_fma_f32 v[100:101], v[80:81], s[88:89], v[106:107]
    v_pk_fma_f32 v[102:103], v[82:83], s[88:89], v[106:107]
    v_exp_f32_e64 v96, v96 clamp
    v_exp_f32_e64 v97, v97 clamp
    v_exp_f32_e64 v98, v98 clamp
    v_exp_f32_e64 v99, v99 clamp
    v_exp_f32_e64 v100, v100 clamp
    v_exp_f32_e64 v101, v101 clamp
    v_exp_f32_e64 v102, v102 clamp
    v_exp_f32_e64 v103, v103 clamp
    v_pk_fma_f32 v[96:97], v[96:97], s[78:79], v[104:105]
    v_pk_fma_f32 v[98:99], v[98:99], s[78:79], v[104:105]
    v_pk_fma_f32 v[100:101], v[100:101], s[78:79], v[104:105]
    v_pk_fma_f32 v[102:103], v[102:103], s[78:79], v[104:105]
    v_pk_fma_f32 v[96:97], v[96:97], v[96:97], v[104:105]
    v_pk_fma_f32 v[98:99], v[98:99], v[98:99], v[104:105]
    v_pk_fma_f32 v[100:101], v[100:101], v[100:101], v[104:105]
    v_pk_fma_f32 v[102:103], v[102:103], v[102:103], v[104:105]
    v_pk_mul_f32 v[108:109], v[96:97], v[98:99]
    v_pk_mul_f32 v[152:153], v[100:101], v[102:103]
    v_mul_f32 v110, v108, v109
    v_mul_f32 v154, v152, v153
    v_rcp_f32 v110, v110
    v_rcp_f32 v154, v154
    s_nop 0
    v_mul_f32 v110, -2.0, v110
    v_mul_f32 v154, -2.0, v154
    v_pk_mul_f32 v[108:109], v[110:111], v[108:109] op_sel:[0,1] op_sel_hi:[0,0]
    v_pk_mul_f32 v[152:153], v[154:155], v[152:153] op_sel:[0,1] op_sel_hi:[0,0]
    v_pk_fma_f32 v[110:111], v[108:109], v[98:99], v[104:105]
    v_pk_fma_f32 v[98:99], v[108:109], v[96:97], v[104:105]
    v_pk_mul_f32 v[96:97], v[110:111], v[76:77]
    v_pk_mul_f32 v[98:99], v[98:99], v[78:79]
    v_pk_fma_f32 v[154:155], v[152:153], v[102:103], v[104:105]
    v_pk_fma_f32 v[102:103], v[152:153], v[100:101], v[104:105]
    v_pk_mul_f32 v[100:101], v[154:155], v[80:81]
    v_pk_mul_f32 v[102:103], v[102:103], v[82:83]
    v_cvt_pk_bf16_f32 v76, v96, v97
    v_cvt_pk_bf16_f32 v77, v98, v99
    v_cvt_pk_bf16_f32 v78, v100, v101
    v_cvt_pk_bf16_f32 v79, v102, v103
    buffer_store_dwordx4 v[76:79], v159, s[32:35], s62 offen offset:1024 sc1
    s_add_u32 s62, s62, 4096
    v_pk_fma_f32 v[88:89], v[56:57], s[88:89], v[106:107]
    v_pk_fma_f32 v[90:91], v[58:59], s[88:89], v[106:107]
    v_pk_fma_f32 v[92:93], v[84:85], s[88:89], v[106:107]
    v_pk_fma_f32 v[94:95], v[86:87], s[88:89], v[106:107]
    v_exp_f32_e64 v88, v88 clamp
    v_exp_f32_e64 v89, v89 clamp
    v_exp_f32_e64 v90, v90 clamp
    v_exp_f32_e64 v91, v91 clamp
    v_exp_f32_e64 v92, v92 clamp
    v_exp_f32_e64 v93, v93 clamp
    v_exp_f32_e64 v94, v94 clamp
    v_exp_f32_e64 v95, v95 clamp
    v_pk_fma_f32 v[88:89], v[88:89], s[78:79], v[104:105]
    v_pk_fma_f32 v[90:91], v[90:91], s[78:79], v[104:105]
    v_pk_fma_f32 v[92:93], v[92:93], s[78:79], v[104:105]
    v_pk_fma_f32 v[94:95], v[94:95], s[78:79], v[104:105]
    v_pk_fma_f32 v[88:89], v[88:89], v[88:89], v[104:105]
    v_pk_fma_f32 v[90:91], v[90:91], v[90:91], v[104:105]
    v_pk_fma_f32 v[92:93], v[92:93], v[92:93], v[104:105]
    v_pk_fma_f32 v[94:95], v[94:95], v[94:95], v[104:105]
    v_pk_mul_f32 v[108:109], v[88:89], v[90:91]
    v_pk_mul_f32 v[152:153], v[92:93], v[94:95]
    v_mul_f32 v110, v108, v109
    v_mul_f32 v154, v152, v153
    v_rcp_f32 v110, v110
    v_rcp_f32 v154, v154
    s_nop 0
    v_mul_f32 v110, -2.0, v110
    v_mul_f32 v154, -2.0, v154
    v_pk_mul_f32 v[108:109], v[110:111], v[108:109] op_sel:[0,1] op_sel_hi:[0,0]
    v_pk_mul_f32 v[152:153], v[154:155], v[152:153] op_sel:[0,1] op_sel_hi:[0,0]
    v_pk_fma_f32 v[110:111], v[108:109], v[90:91], v[104:105]
    v_pk_fma_f32 v[90:91], v[108:109], v[88:89], v[104:105]
    v_pk_mul_f32 v[88:89], v[110:111], v[56:57]
    v_pk_mul_f32 v[90:91], v[90:91], v[58:59]
    v_pk_fma_f32 v[154:155], v[152:153], v[94:95], v[104:105]
    v_pk_fma_f32 v[94:95], v[152:153], v[92:93], v[104:105]
    v_pk_mul_f32 v[92:93], v[154:155], v[84:85]
    v_pk_mul_f32 v[94:95], v[94:95], v[86:87]
    v_cvt_pk_bf16_f32 v56, v88, v89
    v_cvt_pk_bf16_f32 v57, v90, v91
    v_cvt_pk_bf16_f32 v58, v92, v93
    v_cvt_pk_bf16_f32 v59, v94, v95
    buffer_store_dwordx2 v[56:57], v159, s[32:35], s63 offen sc1
    buffer_store_dwordx2 v[58:59], v159, s[32:35], s63 offen offset:1024 sc1
    s_cmp_eq_u32 s47, 0
    s_cbranch_scc0 K1F_nogate
    s_waitcnt vmcnt(8)
    v_mov_b32 v88, 0
    v_dot2c_f32_bf16 v88, v112, v132
    v_dot2c_f32_bf16 v88, v113, v133
    v_dot2c_f32_bf16 v88, v114, v134
    v_dot2c_f32_bf16 v88, v115, v135
    v_dot2c_f32_bf16 v88, v116, v136
    v_dot2c_f32_bf16 v88, v117, v137
    v_dot2c_f32_bf16 v88, v118, v138
    v_dot2c_f32_bf16 v88, v119, v139
    v_dot2c_f32_bf16 v88, v120, v140
    v_dot2c_f32_bf16 v88, v121, v141
    v_dot2c_f32_bf16 v88, v122, v142
    v_dot2c_f32_bf16 v88, v123, v143
    v_dot2c_f32_bf16 v88, v124, v144
    v_dot2c_f32_bf16 v88, v125, v145
    v_dot2c_f32_bf16 v88, v126, v146
    v_dot2c_f32_bf16 v88, v127, v147
    v_dot2c_f32_bf16 v88, v128, v148
    v_dot2c_f32_bf16 v88, v129, v149
    v_dot2c_f32_bf16 v88, v130, v150
    v_dot2c_f32_bf16 v88, v131, v151
    s_nop 3
    v_add_f32_dpp v88, v88, v88 row_ror:8 row_mask:0xf bank_mask:0xf
    s_nop 1
    v_add_f32_dpp v88, v88, v88 row_ror:4 row_mask:0xf bank_mask:0xf
    s_nop 1
    v_add_f32_dpp v88, v88, v88 row_ror:2 row_mask:0xf bank_mask:0xf
    s_nop 1
    v_add_f32_dpp v88, v88, v88 row_ror:1 row_mask:0xf bank_mask:0xf
    s_nop 1
    v_mul_f32 v88, s88, v88
    v_exp_f32 v88, -v88
    s_nop 0
    v_add_f32 v88, 1.0, v88
    v_rcp_f32 v88, v88
    s_add_u32 s84, s10, 16777216
    s_addc_u32 s85, s11, 0
    s_mov_b32 s86, 8192
    s_mov_b32 s87, 0x20000
    v_lshlrev_b32 v156, 2, v156
    v_cmp_eq_u32 vcc, 0, v20
    s_and_saveexec_b64 s[76:77], vcc
    buffer_store_dword v88, v156, s[84:87], 0 offen sc1
    s_mov_b64 exec, s[76:77]
K1F_nogate:
    s_endpgm
K1F_tail:
    s_cmp_eq_u32 s51, 3
    s_cbranch_scc1 K1F_swap
    s_mov_b32 s30, 0
    s_mov_b32 m0, 0x30000
    s_branch K1F_tailed
K1F_swap:
    v_mov_b32 v1, v114
    v_mov_b32 v2, v115
    v_mov_b32 v3, v116
    v_mov_b32 v4, v117
    v_mov_b32 v5, v118
    v_mov_b32 v6, v119
    s_mov_b32 s28, s74
    s_mov_b32 s29, s75
    s_mov_b32 s30, s76
    s_mov_b32 s44, 0
    s_mov_b32 s50, 0
    s_branch K1F_tailed
K1_done:
    s_endpgm
.globl gmix_b_kernel
.p2align 8
.type gmix_b_kernel,@function
gmix_b_kernel:
    s_cmp_ge_u32 s2, 256
    s_cbranch_scc1 K3_done
    s_load_dwordx2 s[8:9], s[0:1], 64
    s_load_dwordx2 s[10:11], s[0:1], 80
    v_lshrrev_b32 v8, 6, v0
    v_and_b32 v9, 63, v0
    v_readfirstlane_b32 s28, v8
    v_lshlrev_b32 v1, 4, v9
    v_add_u32 v2, 4096, v1
    s_and_b32 s3, s2, 7
    s_lshr_b32 s29, s2, 3
    s_lshr_b32 s30, s3, 1
    s_lshl_b32 s30, s30, 3
    s_lshr_b32 s31, s29, 2
    s_and_b32 s29, s29, 3
    s_lshl_b32 s39, s29, 1
    s_add_u32 s39, s39, s31
    s_and_b32 s39, s39, 7
    s_add_u32 s31, s31, s30
    s_and_b32 s30, s3, 1
    s_lshl_b32 s30, s30, 2
    s_add_u32 s30, s30, s29
    s_mov_b32 s29, s31
    s_mul_i32 s34, s28, 18
    s_add_u32 s34, s34, 2
    s_cmp_eq_u32 s28, 0
    s_cselect_b32 s34, 0, s34
    s_cselect_b32 s35, 20, 18
    s_mov_b32 s39, 0
    s_lshl_b32 s31, s39, 12
    s_mul_i32 s32, s39, 5120
    s_lshl_b32 s14, s35, 12
    s_mul_i32 s18, s35, 5120
    s_mul_i32 s37, s29, 74
    s_add_u32 s37, s37, s34
    s_lshl_b32 s37, s37, 12
    s_mul_i32 s36, s30, 74
    s_add_u32 s36, s36, s34
    s_mul_i32 s36, s36, 5120
    s_add_u32 s36, s36, 10485760
    s_mov_b32 s15, 0x20000
    s_mov_b32 s19, 0x20000
    s_mul_i32 s33, s28, 20480
    s_add_u32 s38, s28, 0
    s_and_b32 s38, s38, 3
    s_lshl_b32 s38, s38, 10
    v_add_u32 v3, s38, v1
    s_add_u32 s38, s28, 1
    s_and_b32 s38, s38, 3
    s_lshl_b32 s38, s38, 10
    v_add_u32 v4, s38, v1
    s_add_u32 s38, s28, 2
    s_and_b32 s38, s38, 3
    s_lshl_b32 s38, s38, 10
    v_add_u32 v5, s38, v1
    s_add_u32 s38, s28, 3
    s_and_b32 s38, s38, 3
    s_lshl_b32 s38, s38, 10
    v_add_u32 v6, s38, v1
    s_lshl_b32 s38, s29, 6
    s_lshl_b32 s39, s28, 4
    s_add_u32 s38, s38, s39
    v_and_b32 v10, 15, v9
    v_add_u32 v10, s38, v10
    v_lshlrev_b32 v11, 2, v10
    s_mov_b32 s26, 8192
    s_mov_b32 s27, 0x20000
    s_waitcnt lgkmcnt(0)
    s_add_u32 s24, s10, 16777216
    s_addc_u32 s25, s11, 0
    buffer_load_dword v12, v11, s[24:27], 0 offen
    s_add_u32 s16, s10, s36
    s_addc_u32 s17, s11, 0
    s_add_u32 s12, s10, s37
    s_addc_u32 s13, s11, 0
    s_cmp_eq_u32 s28, 0
    s_cbranch_scc0 K3_pro1
    buffer_load_dwordx4 a[52:55], v1, s[16:19], s32 offen offset:0
    buffer_load_dwordx4 a[56:59], v1, s[16:19], s32 offen offset:1024
    buffer_load_dwordx4 a[60:63], v1, s[16:19], s32 offen offset:2048
    buffer_load_dwordx4 a[64:67], v1, s[16:19], s32 offen offset:3072
    buffer_load_dwordx4 a[68:71], v2, s[16:19], s32 offen
    buffer_load_dwordx4 a[36:39], v3, s[12:15], s31 offen
    buffer_load_dwordx4 a[40:43], v4, s[12:15], s31 offen
    buffer_load_dwordx4 a[44:47], v5, s[12:15], s31 offen
    buffer_load_dwordx4 a[48:51], v6, s[12:15], s31 offen
    s_add_u32 s31, s31, 4096
    s_add_u32 s32, s32, 5120
    buffer_load_dwordx4 a[88:91], v1, s[16:19], s32 offen offset:0
    buffer_load_dwordx4 a[92:95], v1, s[16:19], s32 offen offset:1024
    buffer_load_dwordx4 a[96:99], v1, s[16:19], s32 offen offset:2048
    buffer_load_dwordx4 a[100:103], v1, s[16:19], s32 offen offset:3072
    buffer_load_dwordx4 a[104:107], v2, s[16:19], s32 offen
    buffer_load_dwordx4 a[72:75], v3, s[12:15], s31 offen
    buffer_load_dwordx4 a[76:79], v4, s[12:15], s31 offen
    buffer_load_dwordx4 a[80:83], v5, s[12:15], s31 offen
    buffer_load_dwordx4 a[84:87], v6, s[12:15], s31 offen
    s_add_u32 s31, s31, 4096
    s_add_u32 s32, s32, 5120
    buffer_load_dwordx4 a[16:19], v1, s[16:19], s32 offen offset:0
    buffer_load_dwordx4 a[20:23], v1, s[16:19], s32 offen offset:1024
    buffer_load_dwordx4 a[24:27], v1, s[16:19], s32 offen offset:2048
    buffer_load_dwordx4 a[28:31], v1, s[16:19], s32 offen offset:3072
    buffer_load_dwordx4 a[32:35], v2, s[16:19], s32 offen
    buffer_load_dwordx4 a[0:3], v3, s[12:15], s31 offen
    buffer_load_dwordx4 a[4:7], v4, s[12:15], s31 offen
    buffer_load_dwordx4 a[8:11], v5, s[12:15], s31 offen
    buffer_load_dwordx4 a[12:15], v6, s[12:15], s31 offen
    s_add_u32 s31, s31, 4096
    s_add_u32 s32, s32, 5120
    s_mov_b32 s34, 6
    s_mov_b32 s35, 1
    s_branch K3_common
K3_pro1:
    buffer_load_dwordx4 a[16:19], v1, s[16:19], s32 offen offset:0
    buffer_load_dwordx4 a[20:23], v1, s[16:19], s32 offen offset:1024
    buffer_load_dwordx4 a[24:27], v1, s[16:19], s32 offen offset:2048
    buffer_load_dwordx4 a[28:31], v1, s[16:19], s32 offen offset:3072
    buffer_load_dwordx4 a[32:35], v2, s[16:19], s32 offen
    buffer_load_dwordx4 a[0:3], v3, s[12:15], s31 offen
    buffer_load_dwordx4 a[4:7], v4, s[12:15], s31 offen
    buffer_load_dwordx4 a[8:11], v5, s[12:15], s31 offen
    buffer_load_dwordx4 a[12:15], v6, s[12:15], s31 offen
    s_add_u32 s31, s31, 4096
    s_add_u32 s32, s32, 5120
    buffer_load_dwordx4 a[52:55], v1, s[16:19], s32 offen offset:0
    buffer_load_dwordx4 a[56:59], v1, s[16:19], s32 offen offset:1024
    buffer_load_dwordx4 a[60:63], v1, s[16:19], s32 offen offset:2048
    buffer_load_dwordx4 a[64:67], v1, s[16:19], s32 offen offset:3072
    buffer_load_dwordx4 a[68:71], v2, s[16:19], s32 offen
    buffer_load_dwordx4 a[36:39], v3, s[12:15], s31 offen
    buffer_load_dwordx4 a[40:43], v4, s[12:15], s31 offen
    buffer_load_dwordx4 a[44:47], v5, s[12:15], s31 offen
    buffer_load_dwordx4 a[48:51], v6, s[12:15], s31 offen
    s_add_u32 s31, s31, 4096
    s_add_u32 s32, s32, 5120
    buffer_load_dwordx4 a[88:91], v1, s[16:19], s32 offen offset:0
    buffer_load_dwordx4 a[92:95], v1, s[16:19], s32 offen offset:1024
    buffer_load_dwordx4 a[96:99], v1, s[16:19], s32 offen offset:2048
    buffer_load_dwordx4 a[100:103], v1, s[16:19], s32 offen offset:3072
    buffer_load_dwordx4 a[104:107], v2, s[16:19], s32 offen
    buffer_load_dwordx4 a[72:75], v3, s[12:15], s31 offen
    buffer_load_dwordx4 a[76:79], v4, s[12:15], s31 offen
    buffer_load_dwordx4 a[80:83], v5, s[12:15], s31 offen
    buffer_load_dwordx4 a[84:87], v6, s[12:15], s31 offen
    s_add_u32 s31, s31, 4096
    s_add_u32 s32, s32, 5120
    s_mov_b32 s34, 5
    s_mov_b32 s35, 0
    s_branch K3_common
K3_common:
    s_mov_b32 s20, s8
    s_mov_b32 s21, s9
    s_mov_b32 s22, 2621440
    s_mov_b32 s23, 0x20000
    v_mov_b32 v16, 0
    v_mov_b32 v17, 0
    v_mov_b32 v18, 0
    v_mov_b32 v19, 0
    v_mov_b32 v20, 0
    v_mov_b32 v21, 0
    v_mov_b32 v22, 0
    v_mov_b32 v23, 0
    v_mov_b32 v24, 0
    v_mov_b32 v25, 0
    v_mov_b32 v26, 0
    v_mov_b32 v27, 0
    v_mov_b32 v28, 0
    v_mov_b32 v29, 0
    v_mov_b32 v30, 0
    v_mov_b32 v31, 0
    v_mov_b32 v32, 0
    v_mov_b32 v33, 0
    v_mov_b32 v34, 0
    v_mov_b32 v35, 0
    v_mov_b32 v36, 0
    v_mov_b32 v37, 0
    v_mov_b32 v38, 0
    v_mov_b32 v39, 0
    v_mov_b32 v40, 0
    v_mov_b32 v41, 0
    v_mov_b32 v42, 0
    v_mov_b32 v43, 0
    v_mov_b32 v44, 0
    v_mov_b32 v45, 0
    v_mov_b32 v46, 0
    v_mov_b32 v47, 0
    v_mov_b32 v48, 0
    v_mov_b32 v49, 0
    v_mov_b32 v50, 0
    v_mov_b32 v51, 0
    v_mov_b32 v52, 0
    v_mov_b32 v53, 0
    v_mov_b32 v54, 0
    v_mov_b32 v55, 0
    v_mov_b32 v56, 0
    v_mov_b32 v57, 0
    v_mov_b32 v58, 0
    v_mov_b32 v59, 0
    v_mov_b32 v60, 0
    v_mov_b32 v61, 0
    v_mov_b32 v62, 0
    v_mov_b32 v63, 0
    v_mov_b32 v64, 0
    v_mov_b32 v65, 0
    v_mov_b32 v66, 0
    v_mov_b32 v67, 0
    v_mov_b32 v68, 0
    v_mov_b32 v69, 0
    v_mov_b32 v70, 0
    v_mov_b32 v71, 0
    v_mov_b32 v72, 0
    v_mov_b32 v73, 0
    v_mov_b32 v74, 0
    v_mov_b32 v75, 0
    v_mov_b32 v76, 0
    v_mov_b32 v77, 0
    v_mov_b32 v78, 0
    v_mov_b32 v79, 0
    v_mov_b32 v80, 0
    v_mov_b32 v81, 0
    v_mov_b32 v82, 0
    v_mov_b32 v83, 0
    v_mov_b32 v84, 0
    v_mov_b32 v85, 0
    v_mov_b32 v86, 0
    v_mov_b32 v87, 0
    v_mov_b32 v88, 0
    v_mov_b32 v89, 0
    v_mov_b32 v90, 0
    v_mov_b32 v91, 0
    v_mov_b32 v92, 0
    v_mov_b32 v93, 0
    v_mov_b32 v94, 0
    v_mov_b32 v95, 0
    s_cmp_eq_u32 s35, 1
    s_cbranch_scc1 K3_step1
K3_step0:
    s_waitcnt vmcnt(18)
    v_mfma_f32_16x16x32_bf16 v[16:19], a[16:19], a[0:3], v[16:19]
    v_mfma_f32_16x16x32_bf16 v[36:39], a[16:19], a[4:7], v[36:39]
    v_mfma_f32_16x16x32_bf16 v[56:59], a[16:19], a[8:11], v[56:59]
    v_mfma_f32_16x16x32_bf16 v[76:79], a[16:19], a[12:15], v[76:79]
    buffer_load_dwordx4 a[16:19], v1, s[16:19], s32 offen offset:0
    v_mfma_f32_16x16x32_bf16 v[20:23], a[20:23], a[0:3], v[20:23]
    v_mfma_f32_16x16x32_bf16 v[40:43], a[20:23], a[4:7], v[40:43]
    v_mfma_f32_16x16x32_bf16 v[60:63], a[20:23], a[8:11], v[60:63]
    v_mfma_f32_16x16x32_bf16 v[80:83], a[20:23], a[12:15], v[80:83]
    buffer_load_dwordx4 a[20:23], v1, s[16:19], s32 offen offset:1024
    v_mfma_f32_16x16x32_bf16 v[24:27], a[24:27], a[0:3], v[24:27]
    v_mfma_f32_16x16x32_bf16 v[44:47], a[24:27], a[4:7], v[44:47]
    v_mfma_f32_16x16x32_bf16 v[64:67], a[24:27], a[8:11], v[64:67]
    v_mfma_f32_16x16x32_bf16 v[84:87], a[24:27], a[12:15], v[84:87]
    buffer_load_dwordx4 a[24:27], v1, s[16:19], s32 offen offset:2048
    v_mfma_f32_16x16x32_bf16 v[28:31], a[28:31], a[0:3], v[28:31]
    v_mfma_f32_16x16x32_bf16 v[48:51], a[28:31], a[4:7], v[48:51]
    v_mfma_f32_16x16x32_bf16 v[68:71], a[28:31], a[8:11], v[68:71]
    v_mfma_f32_16x16x32_bf16 v[88:91], a[28:31], a[12:15], v[88:91]
    buffer_load_dwordx4 a[28:31], v1, s[16:19], s32 offen offset:3072
    v_mfma_f32_16x16x32_bf16 v[32:35], a[32:35], a[0:3], v[32:35]
    v_mfma_f32_16x16x32_bf16 v[52:55], a[32:35], a[4:7], v[52:55]
    v_mfma_f32_16x16x32_bf16 v[72:75], a[32:35], a[8:11], v[72:75]
    v_mfma_f32_16x16x32_bf16 v[92:95], a[32:35], a[12:15], v[92:95]
    buffer_load_dwordx4 a[32:35], v2, s[16:19], s32 offen
    buffer_load_dwordx4 a[0:3], v3, s[12:15], s31 offen
    buffer_load_dwordx4 a[4:7], v4, s[12:15], s31 offen
    buffer_load_dwordx4 a[8:11], v5, s[12:15], s31 offen
    buffer_load_dwordx4 a[12:15], v6, s[12:15], s31 offen
    s_add_u32 s31, s31, 4096
    s_add_u32 s32, s32, 5120
K3_step1:
    s_waitcnt vmcnt(18)
    v_mfma_f32_16x16x32_bf16 v[16:19], a[52:55], a[36:39], v[16:19]
    v_mfma_f32_16x16x32_bf16 v[36:39], a[52:55], a[40:43], v[36:39]
    v_mfma_f32_16x16x32_bf16 v[56:59], a[52:55], a[44:47], v[56:59]
    v_mfma_f32_16x16x32_bf16 v[76:79], a[52:55], a[48:51], v[76:79]
    buffer_load_dwordx4 a[52:55], v1, s[16:19], s32 offen offset:0
    v_mfma_f32_16x16x32_bf16 v[20:23], a[56:59], a[36:39], v[20:23]
    v_mfma_f32_16x16x32_bf16 v[40:43], a[56:59], a[40:43], v[40:43]
    v_mfma_f32_16x16x32_bf16 v[60:63], a[56:59], a[44:47], v[60:63]
    v_mfma_f32_16x16x32_bf16 v[80:83], a[56:59], a[48:51], v[80:83]
    buffer_load_dwordx4 a[56:59], v1, s[16:19], s32 offen offset:1024
    v_mfma_f32_16x16x32_bf16 v[24:27], a[60:63], a[36:39], v[24:27]
    v_mfma_f32_16x16x32_bf16 v[44:47], a[60:63], a[40:43], v[44:47]
    v_mfma_f32_16x16x32_bf16 v[64:67], a[60:63], a[44:47], v[64:67]
    v_mfma_f32_16x16x32_bf16 v[84:87], a[60:63], a[48:51], v[84:87]
    buffer_load_dwordx4 a[60:63], v1, s[16:19], s32 offen offset:2048
    v_mfma_f32_16x16x32_bf16 v[28:31], a[64:67], a[36:39], v[28:31]
    v_mfma_f32_16x16x32_bf16 v[48:51], a[64:67], a[40:43], v[48:51]
    v_mfma_f32_16x16x32_bf16 v[68:71], a[64:67], a[44:47], v[68:71]
    v_mfma_f32_16x16x32_bf16 v[88:91], a[64:67], a[48:51], v[88:91]
    buffer_load_dwordx4 a[64:67], v1, s[16:19], s32 offen offset:3072
    v_mfma_f32_16x16x32_bf16 v[32:35], a[68:71], a[36:39], v[32:35]
    v_mfma_f32_16x16x32_bf16 v[52:55], a[68:71], a[40:43], v[52:55]
    v_mfma_f32_16x16x32_bf16 v[72:75], a[68:71], a[44:47], v[72:75]
    v_mfma_f32_16x16x32_bf16 v[92:95], a[68:71], a[48:51], v[92:95]
    buffer_load_dwordx4 a[68:71], v2, s[16:19], s32 offen
    buffer_load_dwordx4 a[36:39], v3, s[12:15], s31 offen
    buffer_load_dwordx4 a[40:43], v4, s[12:15], s31 offen
    buffer_load_dwordx4 a[44:47], v5, s[12:15], s31 offen
    buffer_load_dwordx4 a[48:51], v6, s[12:15], s31 offen
    s_add_u32 s31, s31, 4096
    s_add_u32 s32, s32, 5120
K3_step2:
    s_waitcnt vmcnt(18)
    v_mfma_f32_16x16x32_bf16 v[16:19], a[88:91], a[72:75], v[16:19]
    v_mfma_f32_16x16x32_bf16 v[36:39], a[88:91], a[76:79], v[36:39]
    v_mfma_f32_16x16x32_bf16 v[56:59], a[88:91], a[80:83], v[56:59]
    v_mfma_f32_16x16x32_bf16 v[76:79], a[88:91], a[84:87], v[76:79]
    buffer_load_dwordx4 a[88:91], v1, s[16:19], s32 offen offset:0
    v_mfma_f32_16x16x32_bf16 v[20:23], a[92:95], a[72:75], v[20:23]
    v_mfma_f32_16x16x32_bf16 v[40:43], a[92:95], a[76:79], v[40:43]
    v_mfma_f32_16x16x32_bf16 v[60:63], a[92:95], a[80:83], v[60:63]
    v_mfma_f32_16x16x32_bf16 v[80:83], a[92:95], a[84:87], v[80:83]
    buffer_load_dwordx4 a[92:95], v1, s[16:19], s32 offen offset:1024
    v_mfma_f32_16x16x32_bf16 v[24:27], a[96:99], a[72:75], v[24:27]
    v_mfma_f32_16x16x32_bf16 v[44:47], a[96:99], a[76:79], v[44:47]
    v_mfma_f32_16x16x32_bf16 v[64:67], a[96:99], a[80:83], v[64:67]
    v_mfma_f32_16x16x32_bf16 v[84:87], a[96:99], a[84:87], v[84:87]
    buffer_load_dwordx4 a[96:99], v1, s[16:19], s32 offen offset:2048
    v_mfma_f32_16x16x32_bf16 v[28:31], a[100:103], a[72:75], v[28:31]
    v_mfma_f32_16x16x32_bf16 v[48:51], a[100:103], a[76:79], v[48:51]
    v_mfma_f32_16x16x32_bf16 v[68:71], a[100:103], a[80:83], v[68:71]
    v_mfma_f32_16x16x32_bf16 v[88:91], a[100:103], a[84:87], v[88:91]
    buffer_load_dwordx4 a[100:103], v1, s[16:19], s32 offen offset:3072
    v_mfma_f32_16x16x32_bf16 v[32:35], a[104:107], a[72:75], v[32:35]
    v_mfma_f32_16x16x32_bf16 v[52:55], a[104:107], a[76:79], v[52:55]
    v_mfma_f32_16x16x32_bf16 v[72:75], a[104:107], a[80:83], v[72:75]
    v_mfma_f32_16x16x32_bf16 v[92:95], a[104:107], a[84:87], v[92:95]
    buffer_load_dwordx4 a[104:107], v2, s[16:19], s32 offen
    buffer_load_dwordx4 a[72:75], v3, s[12:15], s31 offen
    buffer_load_dwordx4 a[76:79], v4, s[12:15], s31 offen
    buffer_load_dwordx4 a[80:83], v5, s[12:15], s31 offen
    buffer_load_dwordx4 a[84:87], v6, s[12:15], s31 offen
    s_add_u32 s31, s31, 4096
    s_add_u32 s32, s32, 5120
    s_sub_u32 s34, s34, 1
    s_cmp_lg_u32 s34, 0
    s_cbranch_scc1 K3_step0
    s_waitcnt vmcnt(18)
    v_mfma_f32_16x16x32_bf16 v[16:19], a[16:19], a[0:3], v[16:19]
    v_mfma_f32_16x16x32_bf16 v[36:39], a[16:19], a[4:7], v[36:39]
    v_mfma_f32_16x16x32_bf16 v[56:59], a[16:19], a[8:11], v[56:59]
    v_mfma_f32_16x16x32_bf16 v[76:79], a[16:19], a[12:15], v[76:79]
    v_mfma_f32_16x16x32_bf16 v[20:23], a[20:23], a[0:3], v[20:23]
    v_mfma_f32_16x16x32_bf16 v[40:43], a[20:23], a[4:7], v[40:43]
    v_mfma_f32_16x16x32_bf16 v[60:63], a[20:23], a[8:11], v[60:63]
    v_mfma_f32_16x16x32_bf16 v[80:83], a[20:23], a[12:15], v[80:83]
    v_mfma_f32_16x16x32_bf16 v[24:27], a[24:27], a[0:3], v[24:27]
    v_mfma_f32_16x16x32_bf16 v[44:47], a[24:27], a[4:7], v[44:47]
    v_mfma_f32_16x16x32_bf16 v[64:67], a[24:27], a[8:11], v[64:67]
    v_mfma_f32_16x16x32_bf16 v[84:87], a[24:27], a[12:15], v[84:87]
    v_mfma_f32_16x16x32_bf16 v[28:31], a[28:31], a[0:3], v[28:31]
    v_mfma_f32_16x16x32_bf16 v[48:51], a[28:31], a[4:7], v[48:51]
    v_mfma_f32_16x16x32_bf16 v[68:71], a[28:31], a[8:11], v[68:71]
    v_mfma_f32_16x16x32_bf16 v[88:91], a[28:31], a[12:15], v[88:91]
    v_mfma_f32_16x16x32_bf16 v[32:35], a[32:35], a[0:3], v[32:35]
    v_mfma_f32_16x16x32_bf16 v[52:55], a[32:35], a[4:7], v[52:55]
    v_mfma_f32_16x16x32_bf16 v[72:75], a[32:35], a[8:11], v[72:75]
    v_mfma_f32_16x16x32_bf16 v[92:95], a[32:35], a[12:15], v[92:95]
    s_waitcnt vmcnt(9)
    v_mfma_f32_16x16x32_bf16 v[16:19], a[52:55], a[36:39], v[16:19]
    v_mfma_f32_16x16x32_bf16 v[36:39], a[52:55], a[40:43], v[36:39]
    v_mfma_f32_16x16x32_bf16 v[56:59], a[52:55], a[44:47], v[56:59]
    v_mfma_f32_16x16x32_bf16 v[76:79], a[52:55], a[48:51], v[76:79]
    v_mfma_f32_16x16x32_bf16 v[20:23], a[56:59], a[36:39], v[20:23]
    v_mfma_f32_16x16x32_bf16 v[40:43], a[56:59], a[40:43], v[40:43]
    v_mfma_f32_16x16x32_bf16 v[60:63], a[56:59], a[44:47], v[60:63]
    v_mfma_f32_16x16x32_bf16 v[80:83], a[56:59], a[48:51], v[80:83]
    v_mfma_f32_16x16x32_bf16 v[24:27], a[60:63], a[36:39], v[24:27]
    v_mfma_f32_16x16x32_bf16 v[44:47], a[60:63], a[40:43], v[44:47]
    v_mfma_f32_16x16x32_bf16 v[64:67], a[60:63], a[44:47], v[64:67]
    v_mfma_f32_16x16x32_bf16 v[84:87], a[60:63], a[48:51], v[84:87]
    v_mfma_f32_16x16x32_bf16 v[28:31], a[64:67], a[36:39], v[28:31]
    v_mfma_f32_16x16x32_bf16 v[48:51], a[64:67], a[40:43], v[48:51]
    v_mfma_f32_16x16x32_bf16 v[68:71], a[64:67], a[44:47], v[68:71]
    v_mfma_f32_16x16x32_bf16 v[88:91], a[64:67], a[48:51], v[88:91]
    v_mfma_f32_16x16x32_bf16 v[32:35], a[68:71], a[36:39], v[32:35]
    v_mfma_f32_16x16x32_bf16 v[52:55], a[68:71], a[40:43], v[52:55]
    v_mfma_f32_16x16x32_bf16 v[72:75], a[68:71], a[44:47], v[72:75]
    v_mfma_f32_16x16x32_bf16 v[92:95], a[68:71], a[48:51], v[92:95]
    s_waitcnt vmcnt(0)
    v_mfma_f32_16x16x32_bf16 v[16:19], a[88:91], a[72:75], v[16:19]
    v_mfma_f32_16x16x32_bf16 v[36:39], a[88:91], a[76:79], v[36:39]
    v_mfma_f32_16x16x32_bf16 v[56:59], a[88:91], a[80:83], v[56:59]
    v_mfma_f32_16x16x32_bf16 v[76:79], a[88:91], a[84:87], v[76:79]
    v_mfma_f32_16x16x32_bf16 v[20:23], a[92:95], a[72:75], v[20:23]
    v_mfma_f32_16x16x32_bf16 v[40:43], a[92:95], a[76:79], v[40:43]
    v_mfma_f32_16x16x32_bf16 v[60:63], a[92:95], a[80:83], v[60:63]
    v_mfma_f32_16x16x32_bf16 v[80:83], a[92:95], a[84:87], v[80:83]
    v_mfma_f32_16x16x32_bf16 v[24:27], a[96:99], a[72:75], v[24:27]
    v_mfma_f32_16x16x32_bf16 v[44:47], a[96:99], a[76:79], v[44:47]
    v_mfma_f32_16x16x32_bf16 v[64:67], a[96:99], a[80:83], v[64:67]
    v_mfma_f32_16x16x32_bf16 v[84:87], a[96:99], a[84:87], v[84:87]
    v_mfma_f32_16x16x32_bf16 v[28:31], a[100:103], a[72:75], v[28:31]
    v_mfma_f32_16x16x32_bf16 v[48:51], a[100:103], a[76:79], v[48:51]
    v_mfma_f32_16x16x32_bf16 v[68:71], a[100:103], a[80:83], v[68:71]
    v_mfma_f32_16x16x32_bf16 v[88:91], a[100:103], a[84:87], v[88:91]
    v_mfma_f32_16x16x32_bf16 v[32:35], a[104:107], a[72:75], v[32:35]
    v_mfma_f32_16x16x32_bf16 v[52:55], a[104:107], a[76:79], v[52:55]
    v_mfma_f32_16x16x32_bf16 v[72:75], a[104:107], a[80:83], v[72:75]
    v_mfma_f32_16x16x32_bf16 v[92:95], a[104:107], a[84:87], v[92:95]
    s_add_u32 s36, s28, 1
    s_and_b32 s36, s36, 3
    s_mul_i32 s36, s36, 15360
    v_add_u32 v13, s36, v1
    s_add_u32 s36, s28, 2
    s_and_b32 s36, s36, 3
    s_mul_i32 s36, s36, 15360
    v_add_u32 v14, s36, v1
    s_add_u32 s36, s28, 3
    s_and_b32 s36, s36, 3
    s_mul_i32 s36, s36, 15360
    v_add_u32 v15, s36, v1
    s_mul_i32 s36, s28, 15360
    v_add_u32 v11, s36, v1
    ds_write_b128 v13, v[36:39] offset:0
    ds_write_b128 v13, v[40:43] offset:1024
    ds_write_b128 v13, v[44:47] offset:2048
    ds_write_b128 v13, v[48:51] offset:3072
    ds_write_b128 v13, v[52:55] offset:4096
    ds_write_b128 v14, v[56:59] offset:5120
    ds_write_b128 v14, v[60:63] offset:6144
    ds_write_b128 v14, v[64:67] offset:7168
    ds_write_b128 v14, v[68:71] offset:8192
    ds_write_b128 v14, v[72:75] offset:9216
    ds_write_b128 v15, v[76:79] offset:10240
    ds_write_b128 v15, v[80:83] offset:11264
    ds_write_b128 v15, v[84:87] offset:12288
    ds_write_b128 v15, v[88:91] offset:13312
    ds_write_b128 v15, v[92:95] offset:14336
    v_sub_f32 v13, 1.0, v12
    s_cmp_eq_u32 s28, 0
    s_cselect_b64 vcc, -1, 0
    v_cndmask_b32 v4, v13, v12, vcc
    s_cmp_eq_u32 s28, 1
    s_cselect_b64 vcc, -1, 0
    v_cndmask_b32 v5, v13, v12, vcc
    s_cmp_eq_u32 s28, 2
    s_cselect_b64 vcc, -1, 0
    v_cndmask_b32 v6, v13, v12, vcc
    s_cmp_eq_u32 s28, 3
    s_cselect_b64 vcc, -1, 0
    v_cndmask_b32 v7, v13, v12, vcc
    v_mul_u32_u24 v10, 0x500, v10
    v_lshrrev_b32 v14, 4, v9
    v_lshl_add_u32 v10, v14, 3, v10
    s_mul_i32 s37, s30, 160
    v_add_u32 v10, s37, v10
    v_mul_f32 v16, v4, v16
    v_mul_f32 v17, v4, v17
    v_mul_f32 v18, v4, v18
    v_mul_f32 v19, v4, v19
    v_mul_f32 v20, v4, v20
    v_mul_f32 v21, v4, v21
    v_mul_f32 v22, v4, v22
    v_mul_f32 v23, v4, v23
    v_mul_f32 v24, v4, v24
    v_mul_f32 v25, v4, v25
    v_mul_f32 v26, v4, v26
    v_mul_f32 v27, v4, v27
    v_mul_f32 v28, v4, v28
    v_mul_f32 v29, v4, v29
    v_mul_f32 v30, v4, v30
    v_mul_f32 v31, v4, v31
    v_mul_f32 v32, v4, v32
    v_mul_f32 v33, v4, v33
    v_mul_f32 v34, v4, v34
    v_mul_f32 v35, v4, v35
    s_waitcnt lgkmcnt(0)
    s_barrier
    ds_read_b128 v[36:39], v11 offset:0
    ds_read_b128 v[56:59], v11 offset:5120
    ds_read_b128 v[76:79], v11 offset:10240
    ds_read_b128 v[40:43], v11 offset:1024
    ds_read_b128 v[60:63], v11 offset:6144
    ds_read_b128 v[80:83], v11 offset:11264
    ds_read_b128 v[44:47], v11 offset:2048
    ds_read_b128 v[64:67], v11 offset:7168
    ds_read_b128 v[84:87], v11 offset:12288
    ds_read_b128 v[48:51], v11 offset:3072
    ds_read_b128 v[68:71], v11 offset:8192
    ds_read_b128 v[88:91], v11 offset:13312
    ds_read_b128 v[52:55], v11 offset:4096
    ds_read_b128 v[72:75], v11 offset:9216
    ds_read_b128 v[92:95], v11 offset:14336
    s_waitcnt lgkmcnt(12)
    v_fmac_f32 v16, v5, v36
    v_fmac_f32 v17, v5, v37
    v_fmac_f32 v18, v5, v38
    v_fmac_f32 v19, v5, v39
    v_fmac_f32 v16, v6, v56
    v_fmac_f32 v17, v6, v57
    v_fmac_f32 v18, v6, v58
    v_fmac_f32 v19, v6, v59
    v_fmac_f32 v16, v7, v76
    v_fmac_f32 v17, v7, v77
    v_fmac_f32 v18, v7, v78
    v_fmac_f32 v19, v7, v79
    v_cvt_pk_bf16_f32 v16, v16, v17
    v_cvt_pk_bf16_f32 v17, v18, v19
    buffer_store_dwordx2 v[16:17], v10, s[20:23], 0 offen offset:0
    s_waitcnt lgkmcnt(9)
    v_fmac_f32 v20, v5, v40
    v_fmac_f32 v21, v5, v41
    v_fmac_f32 v22, v5, v42
    v_fmac_f32 v23, v5, v43
    v_fmac_f32 v20, v6, v60
    v_fmac_f32 v21, v6, v61
    v_fmac_f32 v22, v6, v62
    v_fmac_f32 v23, v6, v63
    v_fmac_f32 v20, v7, v80
    v_fmac_f32 v21, v7, v81
    v_fmac_f32 v22, v7, v82
    v_fmac_f32 v23, v7, v83
    v_cvt_pk_bf16_f32 v20, v20, v21
    v_cvt_pk_bf16_f32 v21, v22, v23
    buffer_store_dwordx2 v[20:21], v10, s[20:23], 0 offen offset:32
    s_waitcnt lgkmcnt(6)
    v_fmac_f32 v24, v5, v44
    v_fmac_f32 v25, v5, v45
    v_fmac_f32 v26, v5, v46
    v_fmac_f32 v27, v5, v47
    v_fmac_f32 v24, v6, v64
    v_fmac_f32 v25, v6, v65
    v_fmac_f32 v26, v6, v66
    v_fmac_f32 v27, v6, v67
    v_fmac_f32 v24, v7, v84
    v_fmac_f32 v25, v7, v85
    v_fmac_f32 v26, v7, v86
    v_fmac_f32 v27, v7, v87
    v_cvt_pk_bf16_f32 v24, v24, v25
    v_cvt_pk_bf16_f32 v25, v26, v27
    buffer_store_dwordx2 v[24:25], v10, s[20:23], 0 offen offset:64
    s_waitcnt lgkmcnt(3)
    v_fmac_f32 v28, v5, v48
    v_fmac_f32 v29, v5, v49
    v_fmac_f32 v30, v5, v50
    v_fmac_f32 v31, v5, v51
    v_fmac_f32 v28, v6, v68
    v_fmac_f32 v29, v6, v69
    v_fmac_f32 v30, v6, v70
    v_fmac_f32 v31, v6, v71
    v_fmac_f32 v28, v7, v88
    v_fmac_f32 v29, v7, v89
    v_fmac_f32 v30, v7, v90
    v_fmac_f32 v31, v7, v91
    v_cvt_pk_bf16_f32 v28, v28, v29
    v_cvt_pk_bf16_f32 v29, v30, v31
    buffer_store_dwordx2 v[28:29], v10, s[20:23], 0 offen offset:96
    s_waitcnt lgkmcnt(0)
    v_fmac_f32 v32, v5, v52
    v_fmac_f32 v33, v5, v53
    v_fmac_f32 v34, v5, v54
    v_fmac_f32 v35, v5, v55
    v_fmac_f32 v32, v6, v72
    v_fmac_f32 v33, v6, v73
    v_fmac_f32 v34, v6, v74
    v_fmac_f32 v35, v6, v75
    v_fmac_f32 v32, v7, v92
    v_fmac_f32 v33, v7, v93
    v_fmac_f32 v34, v7, v94
    v_fmac_f32 v35, v7, v95
    v_cvt_pk_bf16_f32 v32, v32, v33
    v_cvt_pk_bf16_f32 v33, v34, v35
    buffer_store_dwordx2 v[32:33], v10, s[20:23], 0 offen offset:128
K3_done:
    s_endpgm
.section .rodata,"a"
.p2align 6
.amdhsa_kernel gmix_a_kernel
  .amdhsa_next_free_vgpr 248
  .amdhsa_next_free_sgpr 100
  .amdhsa_accum_offset 160
  .amdhsa_group_segment_fixed_size 0
  .amdhsa_kernarg_size 88
  .amdhsa_user_sgpr_count 2
  .amdhsa_user_sgpr_kernarg_segment_ptr 1
  .amdhsa_system_sgpr_workgroup_id_x 1
.end_amdhsa_kernel
.p2align 6
.amdhsa_kernel gmix_b_kernel
  .amdhsa_next_free_vgpr 204
  .amdhsa_next_free_sgpr 56
  .amdhsa_accum_offset 96
  .amdhsa_group_segment_fixed_size 0
  .amdhsa_kernarg_size 88
  .amdhsa_user_sgpr_count 2
  .amdhsa_user_sgpr_kernarg_segment_ptr 1
  .amdhsa_system_sgpr_workgroup_id_x 1
.end_amdhsa_kernel
```
